```python
import torch

def _softmax(x, axis=-1):
    return torch.softmax(x, dim=axis)
def _gelu(x):
    return torch.nn.functional.gelu(x, approximate="tanh")
def _silu(x):
    return torch.nn.functional.silu(x)
def _sigmoid(x):
    return torch.sigmoid(x)
def _layernorm(x, axis=-1, eps=1e-5):
    m = x.mean(dim=axis, keepdim=True)
    v = x.var(dim=axis, keepdim=True, unbiased=False)
    return (x - m) / torch.sqrt(v + eps)
def _scatter_add(tgt, idx, src, axis=0):
    return tgt.clone().index_add_(axis, idx, src)
def _segment_sum(src, seg, n):
    out = torch.zeros((n,) + src.shape[1:], dtype=src.dtype)
    return out.index_add_(0, seg, src)
def _pad(x, pw):
    flat = tuple(v for pair in reversed(pw) for v in pair)
    return torch.nn.functional.pad(x, flat)

kernel_name = 'concat_heads__ssm_conv_s4__mha_block__prompt'

def setup_inputs():

    _w = (lambda a: (lambda t: t.to(torch.bfloat16) if t.is_floating_point() else t)(torch.as_tensor(a)))
    def _A_setup():
        B, L, D, N = 1, 2048, 512, 128
        A_re = -(lambda _x: torch.exp(torch.as_tensor(_x)))((lambda *s: torch.randn(*s, dtype=torch.bfloat16) * 6.4)(D, N))
        A_im = torch.pi * (lambda *s: torch.randn(*s, dtype=torch.bfloat16) * 0.1)(D, N)
        B_re = (lambda *s: torch.randn(*s, dtype=torch.bfloat16) * 0.2)(D, N)
        B_im = (lambda *s: torch.randn(*s, dtype=torch.bfloat16) * 0.2)(D, N)
        C_re = (lambda *s: torch.randn(*s, dtype=torch.bfloat16) * 0.2)(D, N)
        C_im = (lambda *s: torch.randn(*s, dtype=torch.bfloat16) * 0.2)(D, N)
        log_dt = (lambda *s: torch.randn(*s, dtype=torch.bfloat16) * 0.1)(D) * 0.5 - 4.0
        Dskip = (lambda *s: torch.randn(*s, dtype=torch.bfloat16) * 0.1)(D)
        return {
            "u": _w((lambda *s: torch.randn(*s, dtype=torch.bfloat16) * 0.05)(B, L, D)),
            "A_re": _w(A_re),
            "A_im": _w(A_im),
            "B_re": _w(B_re),
            "B_im": _w(B_im),
            "C_re": _w(C_re),
            "C_im": _w(C_im),
            "log_dt": _w(log_dt),
            "Dskip": _w(Dskip),
        }
    _A_in = _A_setup()

    def _B_setup():
        B, S, D, H = 1, 2048, 512, 32
        return {
            "x": _w((lambda *s: torch.randn(*s, dtype=torch.bfloat16) * 0.2)(B, S, D)),
            "wqkv": _w((lambda *s: torch.randn(*s, dtype=torch.bfloat16) * 0.2)(D, 3 * D)),
            "wo": _w((lambda *s: torch.randn(*s, dtype=torch.bfloat16) * 0.05)(D, D)),
        }
    _B_in = _B_setup()

    return {
        "A_u": _A_in["u"],
        "A_A_re": _A_in["A_re"],
        "A_A_im": _A_in["A_im"],
        "A_B_re": _A_in["B_re"],
        "A_B_im": _A_in["B_im"],
        "A_C_re": _A_in["C_re"],
        "A_C_im": _A_in["C_im"],
        "A_log_dt": _A_in["log_dt"],
        "A_Dskip": _A_in["Dskip"],
        "B_x": _B_in["x"],
        "B_wqkv": _B_in["wqkv"],
        "B_wo": _B_in["wo"],
    }

def reference(A_u, A_A_re, A_A_im, A_B_re, A_B_im, A_C_re, A_C_im, A_log_dt, A_Dskip, B_x, B_wqkv, B_wo):
    def _A_ref(u, A_re, A_im, B_re, B_im, C_re, C_im, log_dt, Dskip):
        Bsz, L, D = u.shape
        dt = torch.exp(log_dt)[:, None]
        A = A_re + 1j * A_im
        Bc = B_re + 1j * B_im
        Cc = C_re + 1j * C_im
        logdA = dt * A
        dB = dt * Bc
        l = (lambda x, dt: x.to(dt))(torch.arange(L), A_re.dtype)
        P = torch.exp(logdA[:, :, None] * l[None, None, :])
        K = torch.einsum("dn,dnl,dn->dl", Cc, P, dB).real
        L2 = 2 * L
        Kp = _pad(K, ((0, 0), (0, L)))
        up = (lambda x, *d: x.permute(*d))(u, 0, 2, 1)
        up = _pad(up, ((0, 0), (0, 0), (0, L)))
        Kf = (lambda x, axes=(-2,-1): torch.fft.rfft2(x.float(), dim=axes))(Kp[:, None, :], axes=(-2, -1))
        Uf = (lambda x, axes=(-2,-1): torch.fft.rfft2(x.float(), dim=axes))(up[:, :, None, :], axes=(-2, -1))
        Yf = Uf * Kf[None, :, :, :]
        y = (lambda x, s, axes=(-2,-1): torch.fft.irfft2(x, s=s, dim=axes).to(torch.bfloat16))(Yf, (1, L2), axes=(-2, -1))[:, :, 0, :L]
        y = (lambda x, *d: x.permute(*d))(y, 0, 2, 1) + u * Dskip[None, None, :]
        return y

    def _B_ref(x, wqkv, wo):
        B, S, D = x.shape
        H = 32
        Dh = D // H
        qkv = (lambda x, *d: x.permute(*d))((x @ wqkv).reshape(B, S, 3, H, Dh), 2, 0, 3, 1, 4)
        q, k, v = qkv[0], qkv[1], qkv[2]
        scores = torch.einsum("bhqd,bhkd->bhqk", q, k) * (Dh ** -0.5)
        p = _softmax(scores, axis=-1)
        o = torch.einsum("bhqk,bhkd->bhqd", p, v)
        return (lambda x, *d: x.permute(*d))(o, 0, 2, 1, 3).reshape(B, S, D) @ wo

    a = _A_ref(A_u, A_A_re, A_A_im, A_B_re, A_B_im, A_C_re, A_C_im, A_log_dt, A_Dskip)
    b = _B_ref(B_x, B_wqkv, B_wo)
    return torch.concatenate([a, b], axis=-1)
```

```asm
; @launch kernel=k1_kernel grid=(256,1,1) block=(768,1,1) lds=155648
; @launch kernel=k2_kernel grid=(256,1,1) block=(768,1,1) lds=163840
; @launch kernel=k3_kernel grid=(256,1,1) block=(512,1,1) lds=131072
.amdgcn_target "amdgcn-amd-amdhsa--gfx950"
.text
.globl k1_kernel
.p2align 8
.type k1_kernel,@function
k1_kernel:
    s_cmp_ge_u32 s2, 256
    s_cbranch_scc1 k1_end
    s_load_dwordx8 s[32:39], s[0:1], 64
    s_load_dwordx16 s[16:31], s[0:1], 0
    s_load_dwordx2 s[40:41], s[0:1], 112
    v_lshrrev_b32 v1, 6, v0
    v_and_b32 v0, 63, v0
    s_and_b32 s4, s2, 7
    v_readfirstlane_b32 s3, v1
    v_readfirstlane_b32 s94, v1
    s_lshr_b32 s5, s2, 3
    s_and_b32 s15, s3, 3
    s_lshr_b32 s14, s3, 2
    s_cmp_eq_u32 s14, 1
    s_cbranch_scc1 k1_kgen
    s_and_b32 s6, s4, 1
    s_lshl_b32 s6, s6, 2
    s_and_b32 s7, s5, 3
    s_add_u32 s6, s6, s7
    s_lshr_b32 s7, s4, 1
    s_lshl_b32 s7, s7, 3
    s_lshr_b32 s8, s5, 2
    s_add_u32 s7, s7, s8
    s_and_b32 s12, s15, 1
    s_lshr_b32 s13, s15, 1
    s_lshl_b32 s8, s7, 1
    s_add_u32 s8, s8, s12
    s_lshl_b32 s12, s12, 12
    v_lshrrev_b32 v13, 5, v0
    s_cmp_eq_u32 s14, 0
    s_cbranch_scc1 k1_load
k1_gemm:
    s_bfe_u32 s92, s2, 262147
    s_and_b32 s93, s94, 3
    s_lshl2_add_u32 s92, s92, s93
    s_mov_b64 exec, 0
    s_cmp_eq_u32 s92, 0
    s_cbranch_scc1 k1_s14
    s_cmp_eq_u32 s92, 1
    s_cbranch_scc1 k1_s15
    s_cmp_eq_u32 s92, 2
    s_cbranch_scc1 k1_s16
    s_cmp_eq_u32 s92, 3
    s_cbranch_scc1 k1_s17
    s_cmp_eq_u32 s92, 4
    s_cbranch_scc1 k1_s18
    s_cmp_eq_u32 s92, 5
    s_cbranch_scc1 k1_s19
    s_cmp_eq_u32 s92, 6
    s_cbranch_scc1 k1_s20
    s_cmp_eq_u32 s92, 7
    s_cbranch_scc1 k1_s21
    s_cmp_eq_u32 s92, 8
    s_cbranch_scc1 k1_s22
    s_cmp_eq_u32 s92, 9
    s_cbranch_scc1 k1_s23
    s_cmp_eq_u32 s92, 10
    s_cbranch_scc1 k1_s24
    s_cmp_eq_u32 s92, 11
    s_cbranch_scc1 k1_s25
    s_cmp_eq_u32 s92, 12
    s_cbranch_scc1 k1_s26
    s_cmp_eq_u32 s92, 13
    s_cbranch_scc1 k1_s27
    s_cmp_eq_u32 s92, 14
    s_cbranch_scc1 k1_s28
    s_cmp_eq_u32 s92, 15
    s_cbranch_scc1 k1_s29
    s_cmp_eq_u32 s92, 16
    s_cbranch_scc1 k1_s30
    s_cmp_eq_u32 s92, 17
    s_cbranch_scc1 k1_s31
    s_cmp_eq_u32 s92, 18
    s_cbranch_scc1 k1_s32
    s_cmp_eq_u32 s92, 19
    s_cbranch_scc1 k1_s33
    s_cmp_eq_u32 s92, 20
    s_cbranch_scc1 k1_s34
    s_cmp_eq_u32 s92, 21
    s_cbranch_scc1 k1_s0
    s_cmp_eq_u32 s92, 22
    s_cbranch_scc1 k1_s1
    s_cmp_eq_u32 s92, 23
    s_cbranch_scc1 k1_s2
    s_cmp_eq_u32 s92, 24
    s_cbranch_scc1 k1_s3
    s_cmp_eq_u32 s92, 25
    s_cbranch_scc1 k1_s4
    s_cmp_eq_u32 s92, 26
    s_cbranch_scc1 k1_s5
    s_cmp_eq_u32 s92, 27
    s_cbranch_scc1 k1_s6
    s_cmp_eq_u32 s92, 28
    s_cbranch_scc1 k1_s7
    s_cmp_eq_u32 s92, 29
    s_cbranch_scc1 k1_s8
    s_cmp_eq_u32 s92, 30
    s_cbranch_scc1 k1_s9
    s_cmp_eq_u32 s92, 31
    s_cbranch_scc1 k1_s10
    s_cmp_eq_u32 s92, 32
    s_cbranch_scc1 k1_s11
    s_cmp_eq_u32 s92, 33
    s_cbranch_scc1 k1_s12
    s_cmp_eq_u32 s92, 34
    s_cbranch_scc1 k1_s13
k1_ret:
    s_mov_b64 exec, -1
    v_and_b32 v7, 31, v0
    v_bfe_u32 v14, v0, 1, 3
    v_xor_b32 v14, v14, v13
    v_lshlrev_b32 v15, 7, v7
    s_add_u32 s12, s12, 8192
    v_add_u32 v15, s12, v15
    v_lshl_add_u32 v8, v14, 4, v15
    v_xor_b32 v9, 32, v8
    v_xor_b32 v10, 64, v8
    v_xor_b32 v11, 96, v8
    v_lshlrev_b32 v16, 10, v13
    v_bfe_u32 v14, v0, 2, 2
    v_lshl_add_u32 v16, v14, 7, v16
    v_bfe_u32 v14, v0, 3, 1
    v_xor_b32 v14, s13, v14
    v_lshl_add_u32 v16, v14, 6, v16
    v_bfe_u32 v14, v0, 4, 1
    v_lshl_add_u32 v16, v14, 5, v16
    v_and_b32 v14, 3, v0
    v_lshl_add_u32 v16, v14, 3, v16
    v_add_u32 v16, 8192, v16
    v_add_u32 v12, 65536, v8
    v_add_u32 v13, 65536, v9
    v_add_u32 v14, 65536, v10
    v_add_u32 v15, 65536, v11
    v_add_u32 v17, 65536, v16
    v_add_u32 v18, 131072, v16
    s_lshl_b32 s6, s6, 1
    s_add_u32 s6, s6, s13
    s_lshl_b32 s10, s6, 17
    s_lshl_b32 s11, s8, 10
    s_add_u32 s10, s10, s11
    s_add_u32 s10, s10, 0
    s_add_u32 s11, s10, 65536
    s_lshl_b32 s12, s6, 18
    s_lshl_b32 s13, s8, 11
    s_add_u32 s12, s12, s13
    s_add_u32 s12, s12, 2097152
    s_add_u32 s13, s12, 131072
    v_lshlrev_b32 v1, 4, v0
    v_and_b32 v2, 0x33, v0
    v_bfe_u32 v3, v0, 2, 1
k1_s0:
    s_cbranch_execz k1_ret
    v_lshl_or_b32 v2, v3, 3, v2
    v_bfe_u32 v3, v0, 3, 1
    v_lshl_or_b32 v2, v3, 2, v2
    v_lshlrev_b32 v2, 4, v2
    v_and_b32 v3, 15, v0
    v_lshlrev_b32 v3, 4, v3
    v_lshrrev_b32 v4, 5, v0
    v_lshl_add_u32 v3, v4, 8, v3
    v_bfe_u32 v4, v0, 4, 1
    v_lshl_add_u32 v3, v4, 17, v3
    s_mov_b32 s14, 0x3eb8aa3b
    s_mov_b32 s15, 0x3eb8aa3b
    s_waitcnt lgkmcnt(0)
    s_mov_b32 s44, s40
    s_and_b32 s45, s41, 0xffff
    s_mov_b32 s46, 0x1000000
    s_mov_b32 s47, 0x00020000
    s_setprio 2
    s_barrier
    ds_read_b128 v[96:99], v8 offset:0
    ds_read_b64_tr_b16 v[36:37], v16 offset:16384
    ds_read_b64_tr_b16 v[38:39], v16 offset:16896
    ds_read_b128 v[100:103], v9 offset:0
    ds_read_b64_tr_b16 v[40:41], v16 offset:18432
    ds_read_b64_tr_b16 v[42:43], v16 offset:18944
    ds_read_b128 v[104:107], v10 offset:0
    ds_read_b64_tr_b16 v[44:45], v16 offset:20480
    ds_read_b64_tr_b16 v[46:47], v16 offset:20992
    ds_read_b128 v[108:111], v11 offset:0
    ds_read_b64_tr_b16 v[48:49], v16 offset:22528
    ds_read_b64_tr_b16 v[50:51], v16 offset:23040
    ds_read_b128 v[112:115], v8 offset:8192
    ds_read_b64_tr_b16 v[52:53], v16 offset:24576
    ds_read_b64_tr_b16 v[54:55], v16 offset:25088
    ds_read_b128 v[116:119], v9 offset:8192
    ds_read_b64_tr_b16 v[56:57], v16 offset:26624
k1_s1:
    s_cbranch_execz k1_ret
    ds_read_b64_tr_b16 v[58:59], v16 offset:27136
    s_waitcnt lgkmcnt(15)
    v_mfma_f32_32x32x16_bf16 v[64:79], v[36:39], v[96:99], 0
    ds_read_b128 v[120:123], v10 offset:8192
    ds_read_b64_tr_b16 v[60:61], v16 offset:28672
    ds_read_b64_tr_b16 v[62:63], v16 offset:29184
    s_waitcnt lgkmcnt(15)
    v_mfma_f32_32x32x16_bf16 v[64:79], v[40:43], v[100:103], v[64:79]
    ds_read_b128 v[124:127], v11 offset:8192
    ds_read_b64_tr_b16 v[36:37], v16 offset:30720
    ds_read_b64_tr_b16 v[38:39], v16 offset:31232
    s_waitcnt lgkmcnt(15)
    v_mfma_f32_32x32x16_bf16 v[64:79], v[44:47], v[104:107], v[64:79]
    s_barrier
    ds_read_b64_tr_b16 v[40:41], v16 offset:32768
    ds_read_b64_tr_b16 v[42:43], v16 offset:33280
    s_waitcnt lgkmcnt(14)
    v_mfma_f32_32x32x16_bf16 v[64:79], v[48:51], v[108:111], v[64:79]
    ds_read_b64_tr_b16 v[44:45], v16 offset:34816
    ds_read_b64_tr_b16 v[46:47], v16 offset:35328
    s_waitcnt lgkmcnt(13)
    v_mfma_f32_32x32x16_bf16 v[64:79], v[52:55], v[112:115], v[64:79]
    ds_read_b64_tr_b16 v[48:49], v16 offset:36864
    ds_read_b64_tr_b16 v[50:51], v16 offset:37376
    s_waitcnt lgkmcnt(12)
    v_mfma_f32_32x32x16_bf16 v[64:79], v[56:59], v[116:119], v[64:79]
    ds_read_b64_tr_b16 v[52:53], v16 offset:38912
    ds_read_b64_tr_b16 v[54:55], v16 offset:39424
    s_waitcnt lgkmcnt(11)
    v_mfma_f32_32x32x16_bf16 v[64:79], v[60:63], v[120:123], v[64:79]
    ds_read_b64_tr_b16 v[56:57], v16 offset:40960
    ds_read_b64_tr_b16 v[58:59], v16 offset:41472
    s_waitcnt lgkmcnt(10)
    v_mfma_f32_32x32x16_bf16 v[64:79], v[36:39], v[124:127], v[64:79]
    ds_read_b64_tr_b16 v[60:61], v16 offset:43008
    ds_read_b64_tr_b16 v[62:63], v16 offset:43520
k1_s2:
    s_cbranch_execz k1_ret
    s_waitcnt lgkmcnt(10)
    v_mfma_f32_32x32x16_bf16 v[80:95], v[40:43], v[96:99], 0
    ds_read_b64_tr_b16 v[36:37], v16 offset:45056
    ds_read_b64_tr_b16 v[38:39], v16 offset:45568
    s_waitcnt lgkmcnt(10)
    v_mfma_f32_32x32x16_bf16 v[80:95], v[44:47], v[100:103], v[80:95]
    ds_read_b64_tr_b16 v[40:41], v16 offset:47104
    ds_read_b64_tr_b16 v[42:43], v16 offset:47616
    s_waitcnt lgkmcnt(10)
    v_mfma_f32_32x32x16_bf16 v[80:95], v[48:51], v[104:107], v[80:95]
    ds_read_b64_tr_b16 v[44:45], v16 offset:49152
    ds_read_b64_tr_b16 v[46:47], v16 offset:49664
    s_waitcnt lgkmcnt(10)
    v_mfma_f32_32x32x16_bf16 v[80:95], v[52:55], v[108:111], v[80:95]
    ds_read_b64_tr_b16 v[48:49], v16 offset:51200
    ds_read_b64_tr_b16 v[50:51], v16 offset:51712
    s_waitcnt lgkmcnt(10)
    v_mfma_f32_32x32x16_bf16 v[80:95], v[56:59], v[112:115], v[80:95]
    ds_read_b64_tr_b16 v[52:53], v16 offset:53248
    ds_read_b64_tr_b16 v[54:55], v16 offset:53760
    s_waitcnt lgkmcnt(10)
    v_mfma_f32_32x32x16_bf16 v[80:95], v[60:63], v[116:119], v[80:95]
    ds_read_b64_tr_b16 v[56:57], v16 offset:55296
    ds_read_b64_tr_b16 v[58:59], v16 offset:55808
    s_waitcnt lgkmcnt(10)
    v_mfma_f32_32x32x16_bf16 v[80:95], v[36:39], v[120:123], v[80:95]
    ds_read_b64_tr_b16 v[60:61], v16 offset:57344
    ds_read_b64_tr_b16 v[62:63], v16 offset:57856
    s_waitcnt lgkmcnt(10)
    v_mfma_f32_32x32x16_bf16 v[80:95], v[40:43], v[124:127], v[80:95]
    ds_read_b64_tr_b16 v[36:37], v16 offset:59392
    ds_read_b64_tr_b16 v[38:39], v16 offset:59904
    s_waitcnt lgkmcnt(10)
    v_mfma_f32_32x32x16_bf16 v[20:35], v[96:99], v[44:47], 0
    ds_read_b64_tr_b16 v[40:41], v16 offset:61440
    ds_read_b64_tr_b16 v[42:43], v16 offset:61952
k1_s3:
    s_cbranch_execz k1_ret
    s_waitcnt lgkmcnt(10)
    v_mfma_f32_32x32x16_bf16 v[20:35], v[100:103], v[48:51], v[20:35]
    ds_read_b64_tr_b16 v[44:45], v16 offset:63488
    ds_read_b64_tr_b16 v[46:47], v16 offset:64000
    s_waitcnt lgkmcnt(10)
    v_mfma_f32_32x32x16_bf16 v[20:35], v[104:107], v[52:55], v[20:35]
    s_barrier
    ds_read_b128 v[96:99], v12 offset:0
    ds_read_b64_tr_b16 v[48:49], v17 offset:16384
    ds_read_b64_tr_b16 v[50:51], v17 offset:16896
    s_waitcnt lgkmcnt(11)
    v_mfma_f32_32x32x16_bf16 v[20:35], v[108:111], v[56:59], v[20:35]
    ds_read_b128 v[100:103], v13 offset:0
    ds_read_b64_tr_b16 v[52:53], v17 offset:18432
    ds_read_b64_tr_b16 v[54:55], v17 offset:18944
    s_waitcnt lgkmcnt(12)
    v_mfma_f32_32x32x16_bf16 v[20:35], v[112:115], v[60:63], v[20:35]
    ds_read_b128 v[104:107], v14 offset:0
    ds_read_b64_tr_b16 v[56:57], v17 offset:20480
    ds_read_b64_tr_b16 v[58:59], v17 offset:20992
    s_waitcnt lgkmcnt(13)
    v_mfma_f32_32x32x16_bf16 v[20:35], v[116:119], v[36:39], v[20:35]
    ds_read_b128 v[108:111], v15 offset:0
    ds_read_b64_tr_b16 v[60:61], v17 offset:22528
    ds_read_b64_tr_b16 v[62:63], v17 offset:23040
    s_waitcnt lgkmcnt(14)
    v_mfma_f32_32x32x16_bf16 v[20:35], v[120:123], v[40:43], v[20:35]
    ds_read_b128 v[112:115], v12 offset:8192
    ds_read_b64_tr_b16 v[36:37], v17 offset:24576
    ds_read_b64_tr_b16 v[38:39], v17 offset:25088
    s_waitcnt lgkmcnt(15)
    v_mfma_f32_32x32x16_bf16 v[20:35], v[124:127], v[44:47], v[20:35]
    ds_read_b128 v[116:119], v13 offset:8192
    ds_read_b64_tr_b16 v[40:41], v17 offset:26624
    ds_read_b64_tr_b16 v[42:43], v17 offset:27136
    s_waitcnt lgkmcnt(15)
k1_s4:
    s_cbranch_execz k1_ret
    v_mfma_f32_32x32x16_bf16 v[64:79], v[48:51], v[96:99], v[64:79]
    ds_read_b128 v[120:123], v14 offset:8192
    ds_read_b64_tr_b16 v[44:45], v17 offset:28672
    ds_read_b64_tr_b16 v[46:47], v17 offset:29184
    s_waitcnt lgkmcnt(15)
    v_mfma_f32_32x32x16_bf16 v[64:79], v[52:55], v[100:103], v[64:79]
    ds_read_b128 v[124:127], v15 offset:8192
    ds_read_b64_tr_b16 v[48:49], v17 offset:30720
    ds_read_b64_tr_b16 v[50:51], v17 offset:31232
    s_waitcnt lgkmcnt(15)
    v_mfma_f32_32x32x16_bf16 v[64:79], v[56:59], v[104:107], v[64:79]
    s_barrier
    ds_read_b64_tr_b16 v[52:53], v17 offset:32768
    ds_read_b64_tr_b16 v[54:55], v17 offset:33280
    s_waitcnt lgkmcnt(14)
    v_mfma_f32_32x32x16_bf16 v[64:79], v[60:63], v[108:111], v[64:79]
    ds_read_b64_tr_b16 v[56:57], v17 offset:34816
    ds_read_b64_tr_b16 v[58:59], v17 offset:35328
    s_waitcnt lgkmcnt(13)
    v_mfma_f32_32x32x16_bf16 v[64:79], v[36:39], v[112:115], v[64:79]
    ds_read_b64_tr_b16 v[60:61], v17 offset:36864
    ds_read_b64_tr_b16 v[62:63], v17 offset:37376
    s_waitcnt lgkmcnt(12)
    v_mfma_f32_32x32x16_bf16 v[64:79], v[40:43], v[116:119], v[64:79]
    ds_read_b64_tr_b16 v[36:37], v17 offset:38912
    ds_read_b64_tr_b16 v[38:39], v17 offset:39424
    s_waitcnt lgkmcnt(11)
    v_mfma_f32_32x32x16_bf16 v[64:79], v[44:47], v[120:123], v[64:79]
    ds_read_b64_tr_b16 v[40:41], v17 offset:40960
    ds_read_b64_tr_b16 v[42:43], v17 offset:41472
    s_waitcnt lgkmcnt(10)
    v_mfma_f32_32x32x16_bf16 v[64:79], v[48:51], v[124:127], v[64:79]
    ds_read_b64_tr_b16 v[44:45], v17 offset:43008
    ds_read_b64_tr_b16 v[46:47], v17 offset:43520
    s_waitcnt lgkmcnt(10)
    v_mfma_f32_32x32x16_bf16 v[80:95], v[52:55], v[96:99], v[80:95]
k1_s5:
    s_cbranch_execz k1_ret
    ds_read_b64_tr_b16 v[48:49], v17 offset:45056
    ds_read_b64_tr_b16 v[50:51], v17 offset:45568
    s_waitcnt lgkmcnt(10)
    v_mfma_f32_32x32x16_bf16 v[80:95], v[56:59], v[100:103], v[80:95]
    ds_read_b64_tr_b16 v[52:53], v17 offset:47104
    ds_read_b64_tr_b16 v[54:55], v17 offset:47616
    s_waitcnt lgkmcnt(10)
    v_mfma_f32_32x32x16_bf16 v[80:95], v[60:63], v[104:107], v[80:95]
    ds_read_b64_tr_b16 v[56:57], v17 offset:49152
    ds_read_b64_tr_b16 v[58:59], v17 offset:49664
    s_waitcnt lgkmcnt(10)
    v_mfma_f32_32x32x16_bf16 v[80:95], v[36:39], v[108:111], v[80:95]
    ds_read_b64_tr_b16 v[60:61], v17 offset:51200
    ds_read_b64_tr_b16 v[62:63], v17 offset:51712
    s_waitcnt lgkmcnt(10)
    v_mfma_f32_32x32x16_bf16 v[80:95], v[40:43], v[112:115], v[80:95]
    ds_read_b64_tr_b16 v[36:37], v17 offset:53248
    ds_read_b64_tr_b16 v[38:39], v17 offset:53760
    s_waitcnt lgkmcnt(10)
    v_mfma_f32_32x32x16_bf16 v[80:95], v[44:47], v[116:119], v[80:95]
    ds_read_b64_tr_b16 v[40:41], v17 offset:55296
    ds_read_b64_tr_b16 v[42:43], v17 offset:55808
    s_waitcnt lgkmcnt(10)
    v_mfma_f32_32x32x16_bf16 v[80:95], v[48:51], v[120:123], v[80:95]
    ds_read_b64_tr_b16 v[44:45], v17 offset:57344
    ds_read_b64_tr_b16 v[46:47], v17 offset:57856
    s_waitcnt lgkmcnt(10)
    v_mfma_f32_32x32x16_bf16 v[80:95], v[52:55], v[124:127], v[80:95]
    ds_read_b64_tr_b16 v[48:49], v17 offset:59392
    ds_read_b64_tr_b16 v[50:51], v17 offset:59904
    s_waitcnt lgkmcnt(10)
    v_mfma_f32_32x32x16_bf16 v[20:35], v[96:99], v[56:59], v[20:35]
    ds_read_b64_tr_b16 v[52:53], v17 offset:61440
    ds_read_b64_tr_b16 v[54:55], v17 offset:61952
    s_waitcnt lgkmcnt(10)
    v_mfma_f32_32x32x16_bf16 v[20:35], v[100:103], v[60:63], v[20:35]
k1_s6:
    s_cbranch_execz k1_ret
    ds_read_b64_tr_b16 v[56:57], v17 offset:63488
    ds_read_b64_tr_b16 v[58:59], v17 offset:64000
    s_waitcnt lgkmcnt(10)
    v_mfma_f32_32x32x16_bf16 v[20:35], v[104:107], v[36:39], v[20:35]
    s_barrier
    ds_read_b128 v[96:99], v8 offset:0
    ds_read_b64_tr_b16 v[60:61], v18 offset:0
    ds_read_b64_tr_b16 v[62:63], v18 offset:512
    s_waitcnt lgkmcnt(11)
    v_mfma_f32_32x32x16_bf16 v[20:35], v[108:111], v[40:43], v[20:35]
    ds_read_b128 v[100:103], v9 offset:0
    ds_read_b64_tr_b16 v[36:37], v18 offset:2048
    ds_read_b64_tr_b16 v[38:39], v18 offset:2560
    s_waitcnt lgkmcnt(12)
    v_mfma_f32_32x32x16_bf16 v[20:35], v[112:115], v[44:47], v[20:35]
    ds_read_b128 v[104:107], v10 offset:0
    ds_read_b64_tr_b16 v[40:41], v18 offset:4096
    ds_read_b64_tr_b16 v[42:43], v18 offset:4608
    s_waitcnt lgkmcnt(13)
    v_mfma_f32_32x32x16_bf16 v[20:35], v[116:119], v[48:51], v[20:35]
    ds_read_b128 v[108:111], v11 offset:0
    ds_read_b64_tr_b16 v[44:45], v18 offset:6144
    ds_read_b64_tr_b16 v[46:47], v18 offset:6656
    s_waitcnt lgkmcnt(14)
    v_mfma_f32_32x32x16_bf16 v[20:35], v[120:123], v[52:55], v[20:35]
    ds_read_b128 v[112:115], v8 offset:8192
    ds_read_b64_tr_b16 v[48:49], v18 offset:8192
    ds_read_b64_tr_b16 v[50:51], v18 offset:8704
    s_waitcnt lgkmcnt(15)
    v_mfma_f32_32x32x16_bf16 v[20:35], v[124:127], v[56:59], v[20:35]
    ds_read_b128 v[116:119], v9 offset:8192
    ds_read_b64_tr_b16 v[52:53], v18 offset:10240
    ds_read_b64_tr_b16 v[54:55], v18 offset:10752
    s_waitcnt lgkmcnt(15)
    v_mfma_f32_32x32x16_bf16 v[64:79], v[60:63], v[96:99], v[64:79]
    ds_read_b128 v[120:123], v10 offset:8192
k1_s7:
    s_cbranch_execz k1_ret
    ds_read_b64_tr_b16 v[56:57], v18 offset:12288
    ds_read_b64_tr_b16 v[58:59], v18 offset:12800
    s_waitcnt lgkmcnt(15)
    v_mfma_f32_32x32x16_bf16 v[64:79], v[36:39], v[100:103], v[64:79]
    ds_read_b128 v[124:127], v11 offset:8192
    ds_read_b64_tr_b16 v[60:61], v18 offset:14336
    ds_read_b64_tr_b16 v[62:63], v18 offset:14848
    s_waitcnt lgkmcnt(15)
    v_mfma_f32_32x32x16_bf16 v[64:79], v[40:43], v[104:107], v[64:79]
    s_barrier
    ds_read_b128 v[128:131], v8 offset:16384
    ds_read_b64_tr_b16 v[36:37], v16 offset:32768
    ds_read_b64_tr_b16 v[38:39], v16 offset:33280
    s_waitcnt lgkmcnt(15)
    v_mfma_f32_32x32x16_bf16 v[64:79], v[44:47], v[108:111], v[64:79]
    ds_read_b128 v[132:135], v9 offset:16384
    ds_read_b64_tr_b16 v[40:41], v16 offset:34816
    ds_read_b64_tr_b16 v[42:43], v16 offset:35328
    s_waitcnt lgkmcnt(15)
    v_mfma_f32_32x32x16_bf16 v[64:79], v[48:51], v[112:115], v[64:79]
    ds_read_b128 v[136:139], v10 offset:16384
    ds_read_b64_tr_b16 v[44:45], v16 offset:36864
    ds_read_b64_tr_b16 v[46:47], v16 offset:37376
    s_waitcnt lgkmcnt(15)
    v_mfma_f32_32x32x16_bf16 v[64:79], v[52:55], v[116:119], v[64:79]
    ds_read_b128 v[140:143], v11 offset:16384
    ds_read_b64_tr_b16 v[48:49], v16 offset:38912
    ds_read_b64_tr_b16 v[50:51], v16 offset:39424
    s_waitcnt lgkmcnt(15)
    v_mfma_f32_32x32x16_bf16 v[64:79], v[56:59], v[120:123], v[64:79]
    ds_read_b128 v[144:147], v8 offset:24576
    ds_read_b64_tr_b16 v[52:53], v16 offset:40960
    ds_read_b64_tr_b16 v[54:55], v16 offset:41472
    s_waitcnt lgkmcnt(15)
    v_mfma_f32_32x32x16_bf16 v[64:79], v[60:63], v[124:127], v[64:79]
    ds_read_b128 v[148:151], v9 offset:24576
k1_s8:
    s_cbranch_execz k1_ret
    ds_read_b64_tr_b16 v[56:57], v16 offset:43008
    ds_read_b64_tr_b16 v[58:59], v16 offset:43520
    s_waitcnt lgkmcnt(15)
    v_mfma_f32_32x32x16_bf16 v[64:79], v[36:39], v[128:131], v[64:79]
    ds_read_b128 v[152:155], v10 offset:24576
    ds_read_b64_tr_b16 v[60:61], v16 offset:45056
    ds_read_b64_tr_b16 v[62:63], v16 offset:45568
    s_waitcnt lgkmcnt(15)
    v_mfma_f32_32x32x16_bf16 v[64:79], v[40:43], v[132:135], v[64:79]
    ds_read_b128 v[156:159], v11 offset:24576
    ds_read_b64_tr_b16 v[36:37], v16 offset:47104
    ds_read_b64_tr_b16 v[38:39], v16 offset:47616
    s_waitcnt lgkmcnt(15)
    v_mfma_f32_32x32x16_bf16 v[64:79], v[44:47], v[136:139], v[64:79]
    s_barrier
    ds_read_b64_tr_b16 v[40:41], v16 offset:49152
    ds_read_b64_tr_b16 v[42:43], v16 offset:49664
    s_waitcnt lgkmcnt(14)
    v_mfma_f32_32x32x16_bf16 v[64:79], v[48:51], v[140:143], v[64:79]
    ds_read_b64_tr_b16 v[44:45], v16 offset:51200
    ds_read_b64_tr_b16 v[46:47], v16 offset:51712
    s_waitcnt lgkmcnt(13)
    v_mfma_f32_32x32x16_bf16 v[64:79], v[52:55], v[144:147], v[64:79]
    ds_read_b64_tr_b16 v[48:49], v16 offset:53248
    ds_read_b64_tr_b16 v[50:51], v16 offset:53760
    s_waitcnt lgkmcnt(12)
    v_mfma_f32_32x32x16_bf16 v[64:79], v[56:59], v[148:151], v[64:79]
    ds_read_b64_tr_b16 v[52:53], v16 offset:55296
    ds_read_b64_tr_b16 v[54:55], v16 offset:55808
    s_waitcnt lgkmcnt(11)
    v_mfma_f32_32x32x16_bf16 v[64:79], v[60:63], v[152:155], v[64:79]
    ds_read_b64_tr_b16 v[56:57], v16 offset:57344
    ds_read_b64_tr_b16 v[58:59], v16 offset:57856
    s_waitcnt lgkmcnt(10)
    v_mfma_f32_32x32x16_bf16 v[64:79], v[36:39], v[156:159], v[64:79]
    ds_read_b64_tr_b16 v[60:61], v16 offset:59392
k1_s9:
    s_cbranch_execz k1_ret
    ds_read_b64_tr_b16 v[62:63], v16 offset:59904
    s_waitcnt lgkmcnt(10)
    v_mfma_f32_32x32x16_bf16 v[80:95], v[40:43], v[96:99], v[80:95]
    ds_read_b64_tr_b16 v[36:37], v16 offset:61440
    ds_read_b64_tr_b16 v[38:39], v16 offset:61952
    s_waitcnt lgkmcnt(10)
    v_mfma_f32_32x32x16_bf16 v[80:95], v[44:47], v[100:103], v[80:95]
    ds_read_b64_tr_b16 v[40:41], v16 offset:63488
    ds_read_b64_tr_b16 v[42:43], v16 offset:64000
    v_pk_mul_f32 v[64:65], v[64:65], s[14:15]
    v_cvt_pk_bf16_f32 v64, v64, v65
    s_waitcnt lgkmcnt(10)
    v_mfma_f32_32x32x16_bf16 v[80:95], v[48:51], v[104:107], v[80:95]
    ds_read_b64_tr_b16 v[44:45], v17 offset:0
    ds_read_b64_tr_b16 v[46:47], v17 offset:512
    v_pk_mul_f32 v[66:67], v[66:67], s[14:15]
    v_cvt_pk_bf16_f32 v65, v66, v67
    s_waitcnt lgkmcnt(10)
    v_mfma_f32_32x32x16_bf16 v[80:95], v[52:55], v[108:111], v[80:95]
    ds_read_b64_tr_b16 v[48:49], v17 offset:2048
    ds_read_b64_tr_b16 v[50:51], v17 offset:2560
    v_pk_mul_f32 v[68:69], v[68:69], s[14:15]
    v_cvt_pk_bf16_f32 v66, v68, v69
    s_waitcnt lgkmcnt(10)
    v_mfma_f32_32x32x16_bf16 v[80:95], v[56:59], v[112:115], v[80:95]
    ds_read_b64_tr_b16 v[52:53], v17 offset:4096
    ds_read_b64_tr_b16 v[54:55], v17 offset:4608
    v_pk_mul_f32 v[70:71], v[70:71], s[14:15]
    v_cvt_pk_bf16_f32 v67, v70, v71
    s_waitcnt lgkmcnt(10)
    v_mfma_f32_32x32x16_bf16 v[80:95], v[60:63], v[116:119], v[80:95]
    ds_read_b64_tr_b16 v[56:57], v17 offset:6144
    ds_read_b64_tr_b16 v[58:59], v17 offset:6656
    buffer_store_dwordx4 v[64:67], v1, s[44:47], s10 offen sc0 sc1
    v_pk_mul_f32 v[72:73], v[72:73], s[14:15]
k1_s10:
    s_cbranch_execz k1_ret
    s_waitcnt lgkmcnt(10)
    v_mfma_f32_32x32x16_bf16 v[80:95], v[36:39], v[120:123], v[80:95]
    ds_read_b64_tr_b16 v[60:61], v17 offset:8192
    ds_read_b64_tr_b16 v[62:63], v17 offset:8704
    v_cvt_pk_bf16_f32 v68, v72, v73
    v_pk_mul_f32 v[74:75], v[74:75], s[14:15]
    s_waitcnt lgkmcnt(10)
    v_mfma_f32_32x32x16_bf16 v[80:95], v[40:43], v[124:127], v[80:95]
    ds_read_b64_tr_b16 v[36:37], v17 offset:10240
    ds_read_b64_tr_b16 v[38:39], v17 offset:10752
    v_cvt_pk_bf16_f32 v69, v74, v75
    v_pk_mul_f32 v[76:77], v[76:77], s[14:15]
    s_waitcnt lgkmcnt(10)
    v_mfma_f32_32x32x16_bf16 v[80:95], v[44:47], v[128:131], v[80:95]
    ds_read_b64_tr_b16 v[40:41], v17 offset:12288
    ds_read_b64_tr_b16 v[42:43], v17 offset:12800
    v_cvt_pk_bf16_f32 v70, v76, v77
    v_pk_mul_f32 v[78:79], v[78:79], s[14:15]
    s_waitcnt lgkmcnt(10)
    v_mfma_f32_32x32x16_bf16 v[80:95], v[48:51], v[132:135], v[80:95]
    ds_read_b64_tr_b16 v[44:45], v17 offset:14336
    ds_read_b64_tr_b16 v[46:47], v17 offset:14848
    v_cvt_pk_bf16_f32 v71, v78, v79
    buffer_store_dwordx4 v[68:71], v1, s[44:47], s11 offen sc0 sc1
    s_waitcnt lgkmcnt(10)
    v_mfma_f32_32x32x16_bf16 v[80:95], v[52:55], v[136:139], v[80:95]
    s_barrier
    ds_read_b64_tr_b16 v[48:49], v17 offset:16384
    ds_read_b64_tr_b16 v[50:51], v17 offset:16896
    s_waitcnt lgkmcnt(10)
    v_mfma_f32_32x32x16_bf16 v[80:95], v[56:59], v[140:143], v[80:95]
    ds_read_b64_tr_b16 v[52:53], v17 offset:18432
    ds_read_b64_tr_b16 v[54:55], v17 offset:18944
    s_waitcnt lgkmcnt(10)
    v_mfma_f32_32x32x16_bf16 v[80:95], v[60:63], v[144:147], v[80:95]
    ds_read_b64_tr_b16 v[56:57], v17 offset:20480
k1_s11:
    s_cbranch_execz k1_ret
    ds_read_b64_tr_b16 v[58:59], v17 offset:20992
    s_waitcnt lgkmcnt(10)
    v_mfma_f32_32x32x16_bf16 v[80:95], v[36:39], v[148:151], v[80:95]
    ds_read_b64_tr_b16 v[60:61], v17 offset:22528
    ds_read_b64_tr_b16 v[62:63], v17 offset:23040
    s_waitcnt lgkmcnt(10)
    v_mfma_f32_32x32x16_bf16 v[80:95], v[40:43], v[152:155], v[80:95]
    ds_read_b64_tr_b16 v[36:37], v17 offset:24576
    ds_read_b64_tr_b16 v[38:39], v17 offset:25088
    s_waitcnt lgkmcnt(10)
    v_mfma_f32_32x32x16_bf16 v[80:95], v[44:47], v[156:159], v[80:95]
    ds_read_b64_tr_b16 v[40:41], v17 offset:26624
    ds_read_b64_tr_b16 v[42:43], v17 offset:27136
    s_waitcnt lgkmcnt(10)
    v_mfma_f32_32x32x16_bf16 v[20:35], v[96:99], v[48:51], v[20:35]
    ds_read_b64_tr_b16 v[44:45], v17 offset:28672
    ds_read_b64_tr_b16 v[46:47], v17 offset:29184
    s_waitcnt lgkmcnt(10)
    v_mfma_f32_32x32x16_bf16 v[20:35], v[100:103], v[52:55], v[20:35]
    ds_read_b64_tr_b16 v[48:49], v17 offset:30720
    ds_read_b64_tr_b16 v[50:51], v17 offset:31232
    v_cvt_pk_bf16_f32 v80, v80, v81
    v_cvt_pk_bf16_f32 v81, v82, v83
    s_waitcnt lgkmcnt(10)
    v_mfma_f32_32x32x16_bf16 v[20:35], v[104:107], v[56:59], v[20:35]
    s_barrier
    ds_read_b64_tr_b16 v[52:53], v17 offset:32768
    ds_read_b64_tr_b16 v[54:55], v17 offset:33280
    v_cvt_pk_bf16_f32 v82, v84, v85
    v_cvt_pk_bf16_f32 v83, v86, v87
    s_waitcnt lgkmcnt(10)
    v_mfma_f32_32x32x16_bf16 v[20:35], v[108:111], v[60:63], v[20:35]
    ds_read_b64_tr_b16 v[56:57], v17 offset:34816
    ds_read_b64_tr_b16 v[58:59], v17 offset:35328
    buffer_store_dwordx4 v[80:83], v2, s[44:47], s12 offen sc0 sc1
    v_cvt_pk_bf16_f32 v84, v88, v89
k1_s12:
    s_cbranch_execz k1_ret
    s_waitcnt lgkmcnt(10)
    v_mfma_f32_32x32x16_bf16 v[20:35], v[112:115], v[36:39], v[20:35]
    ds_read_b64_tr_b16 v[60:61], v17 offset:36864
    ds_read_b64_tr_b16 v[62:63], v17 offset:37376
    v_cvt_pk_bf16_f32 v85, v90, v91
    v_cvt_pk_bf16_f32 v86, v92, v93
    s_waitcnt lgkmcnt(10)
    v_mfma_f32_32x32x16_bf16 v[20:35], v[116:119], v[40:43], v[20:35]
    ds_read_b64_tr_b16 v[36:37], v17 offset:38912
    ds_read_b64_tr_b16 v[38:39], v17 offset:39424
    v_cvt_pk_bf16_f32 v87, v94, v95
    buffer_store_dwordx4 v[84:87], v2, s[44:47], s13 offen sc0 sc1
    s_waitcnt lgkmcnt(10)
    v_mfma_f32_32x32x16_bf16 v[20:35], v[120:123], v[44:47], v[20:35]
    ds_read_b64_tr_b16 v[40:41], v17 offset:40960
    ds_read_b64_tr_b16 v[42:43], v17 offset:41472
    s_waitcnt lgkmcnt(10)
    v_mfma_f32_32x32x16_bf16 v[20:35], v[124:127], v[48:51], v[20:35]
    ds_read_b64_tr_b16 v[44:45], v17 offset:43008
    ds_read_b64_tr_b16 v[46:47], v17 offset:43520
    s_waitcnt lgkmcnt(10)
    v_mfma_f32_32x32x16_bf16 v[20:35], v[128:131], v[52:55], v[20:35]
    ds_read_b64_tr_b16 v[48:49], v17 offset:45056
    ds_read_b64_tr_b16 v[50:51], v17 offset:45568
    s_waitcnt lgkmcnt(10)
    v_mfma_f32_32x32x16_bf16 v[20:35], v[132:135], v[56:59], v[20:35]
    ds_read_b64_tr_b16 v[52:53], v17 offset:47104
    ds_read_b64_tr_b16 v[54:55], v17 offset:47616
    s_waitcnt lgkmcnt(10)
    v_mfma_f32_32x32x16_bf16 v[20:35], v[136:139], v[60:63], v[20:35]
    s_waitcnt lgkmcnt(8)
    v_mfma_f32_32x32x16_bf16 v[20:35], v[140:143], v[36:39], v[20:35]
    s_waitcnt lgkmcnt(6)
    v_mfma_f32_32x32x16_bf16 v[20:35], v[144:147], v[40:43], v[20:35]
    s_waitcnt lgkmcnt(4)
    v_mfma_f32_32x32x16_bf16 v[20:35], v[148:151], v[44:47], v[20:35]
    s_waitcnt lgkmcnt(2)
k1_s13:
    s_cbranch_execz k1_ret
    v_mfma_f32_32x32x16_bf16 v[20:35], v[152:155], v[48:51], v[20:35]
    s_waitcnt lgkmcnt(0)
    v_mfma_f32_32x32x16_bf16 v[20:35], v[156:159], v[52:55], v[20:35]
    s_nop 11
    s_nop 1
    v_cvt_pk_bf16_f32 v20, v20, v21
    v_cvt_pk_bf16_f32 v21, v22, v23
    v_cvt_pk_bf16_f32 v22, v24, v25
    v_cvt_pk_bf16_f32 v23, v26, v27
    buffer_store_dwordx4 v[20:23], v3, s[44:47], s12 offen offset:1024 sc0 sc1
    v_cvt_pk_bf16_f32 v24, v28, v29
    v_cvt_pk_bf16_f32 v25, v30, v31
    v_cvt_pk_bf16_f32 v26, v32, v33
    v_cvt_pk_bf16_f32 v27, v34, v35
    buffer_store_dwordx4 v[24:27], v3, s[44:47], s12 offen offset:1536 sc0 sc1
    s_endpgm
    .p2align 7
k1_load:
    s_lshl_b32 s9, s8, 15
    s_lshl_b32 s10, s13, 14
    s_add_u32 s9, s9, s10
    s_lshl_b32 s10, s13, 11
    s_add_u32 s12, s12, s10
    v_lshrrev_b32 v1, 3, v0
    v_and_b32 v7, 7, v0
    v_lshrrev_b32 v8, 4, v0
    v_xor_b32 v4, v7, v8
    v_lshlrev_b32 v5, 10, v1
    v_lshl_add_u32 v2, v4, 4, v5
    v_xor_b32 v3, 64, v2
    v_add_u32 v3, 7168, v3
    s_mul_i32 s10, s15, 98304
    s_lshl_b32 s11, s6, 7
    s_add_u32 s10, s10, s11
    s_lshl_b32 s13, s15, 12
    v_and_b32 v8, 1, v8
    v_lshlrev_b32 v8, 2, v8
    v_xor_b32 v7, v7, v8
    v_mul_u32_u24 v8, 3072, v1
    v_lshl_add_u32 v10, v7, 4, v8
    v_add_u32 v10, s10, v10
    v_add_u32 v11, 23552, v10
    v_add_u32 v12, 47104, v10
    v_add_u32 v13, 70656, v10
    s_add_u32 s60, s6, s7
k1_s14:
    s_cbranch_execz k1_ret
    s_and_b32 s60, s60, 3
    s_lshl_b32 s56, s60, 8
    s_add_u32 s56, s56, s9
    s_mul_i32 s96, s60, 393216
    s_add_u32 s60, s60, 1
    s_and_b32 s60, s60, 3
    s_lshl_b32 s57, s60, 8
    s_add_u32 s57, s57, s9
    s_mul_i32 s97, s60, 393216
    s_add_u32 s60, s60, 1
    s_and_b32 s60, s60, 3
    s_lshl_b32 s58, s60, 8
    s_add_u32 s58, s58, s9
    s_mul_i32 s98, s60, 393216
    s_add_u32 s60, s60, 1
    s_and_b32 s60, s60, 3
    s_lshl_b32 s59, s60, 8
    s_add_u32 s59, s59, s9
    s_mul_i32 s99, s60, 393216
    s_add_u32 s60, s60, 1
    s_mov_b32 s50, 0x200000
    s_mov_b32 s51, 0x00020000
    s_mov_b32 s54, 0x180000
    s_mov_b32 s55, 0x00020000
    s_waitcnt lgkmcnt(0)
    s_mov_b32 s48, s34
    s_and_b32 s49, s35, 0xffff
    s_mov_b32 s52, s36
    s_and_b32 s53, s37, 0xffff
    s_add_u32 m0, s12, 8192
    s_add_u32 s14, s56, 128
    buffer_load_dwordx4 v2, s[48:51], s56 offen lds
    buffer_load_dwordx4 v3, s[48:51], s56 offen offset:1024 lds
    s_add_u32 m0, s12, 16384
    s_nop 0
    buffer_load_dwordx4 v2, s[48:51], s14 offen lds
    buffer_load_dwordx4 v3, s[48:51], s14 offen offset:1024 lds
    s_add_u32 m0, s13, 24576
    s_add_u32 s14, s96, 0
    buffer_load_dwordx4 v10, s[52:55], s14 offen offset:0 lds
    buffer_load_dwordx4 v11, s[52:55], s14 offen offset:1024 lds
    buffer_load_dwordx4 v12, s[52:55], s14 offen offset:2048 lds
k1_s15:
    s_cbranch_execz k1_ret
    buffer_load_dwordx4 v13, s[52:55], s14 offen offset:3072 lds
    s_add_u32 m0, s13, 40960
    s_add_u32 s14, s96, 1024
    buffer_load_dwordx4 v10, s[52:55], s14 offen offset:0 lds
    buffer_load_dwordx4 v11, s[52:55], s14 offen offset:1024 lds
    buffer_load_dwordx4 v12, s[52:55], s14 offen offset:2048 lds
    buffer_load_dwordx4 v13, s[52:55], s14 offen offset:3072 lds
    s_add_u32 m0, s13, 57344
    s_add_u32 s14, s96, 2048
    buffer_load_dwordx4 v10, s[52:55], s14 offen offset:0 lds
    buffer_load_dwordx4 v11, s[52:55], s14 offen offset:1024 lds
    buffer_load_dwordx4 v12, s[52:55], s14 offen offset:2048 lds
    buffer_load_dwordx4 v13, s[52:55], s14 offen offset:3072 lds
    s_add_u32 m0, s12, 73728
    s_add_u32 s14, s57, 128
    buffer_load_dwordx4 v2, s[48:51], s57 offen lds
    buffer_load_dwordx4 v3, s[48:51], s57 offen offset:1024 lds
    s_add_u32 m0, s12, 81920
    s_nop 0
    buffer_load_dwordx4 v2, s[48:51], s14 offen lds
    buffer_load_dwordx4 v3, s[48:51], s14 offen offset:1024 lds
    s_waitcnt vmcnt(12)
    s_barrier
    s_add_u32 m0, s13, 90112
    s_add_u32 s14, s97, 0
    buffer_load_dwordx4 v10, s[52:55], s14 offen offset:0 lds
    buffer_load_dwordx4 v11, s[52:55], s14 offen offset:1024 lds
    buffer_load_dwordx4 v12, s[52:55], s14 offen offset:2048 lds
    buffer_load_dwordx4 v13, s[52:55], s14 offen offset:3072 lds
    s_add_u32 m0, s13, 106496
    s_add_u32 s14, s97, 1024
    buffer_load_dwordx4 v10, s[52:55], s14 offen offset:0 lds
    buffer_load_dwordx4 v11, s[52:55], s14 offen offset:1024 lds
    buffer_load_dwordx4 v12, s[52:55], s14 offen offset:2048 lds
k1_s16:
    s_cbranch_execz k1_ret
    buffer_load_dwordx4 v13, s[52:55], s14 offen offset:3072 lds
    s_waitcnt vmcnt(12)
    s_barrier
    s_add_u32 m0, s13, 122880
    s_add_u32 s14, s97, 2048
    buffer_load_dwordx4 v10, s[52:55], s14 offen offset:0 lds
    buffer_load_dwordx4 v11, s[52:55], s14 offen offset:1024 lds
    buffer_load_dwordx4 v12, s[52:55], s14 offen offset:2048 lds
    buffer_load_dwordx4 v13, s[52:55], s14 offen offset:3072 lds
    s_add_u32 m0, s13, 139264
    s_add_u32 s14, s98, 0
    buffer_load_dwordx4 v10, s[52:55], s14 offen offset:0 lds
    buffer_load_dwordx4 v11, s[52:55], s14 offen offset:1024 lds
    buffer_load_dwordx4 v12, s[52:55], s14 offen offset:2048 lds
    buffer_load_dwordx4 v13, s[52:55], s14 offen offset:3072 lds
    s_waitcnt vmcnt(12)
    s_barrier
    s_add_u32 m0, s12, 8192
    s_add_u32 s14, s58, 128
    buffer_load_dwordx4 v2, s[48:51], s58 offen lds
    buffer_load_dwordx4 v3, s[48:51], s58 offen offset:1024 lds
    s_add_u32 m0, s12, 16384
    s_nop 0
    buffer_load_dwordx4 v2, s[48:51], s14 offen lds
    buffer_load_dwordx4 v3, s[48:51], s14 offen offset:1024 lds
    s_add_u32 m0, s12, 24576
    s_add_u32 s14, s59, 128
    buffer_load_dwordx4 v2, s[48:51], s59 offen lds
    buffer_load_dwordx4 v3, s[48:51], s59 offen offset:1024 lds
    s_add_u32 m0, s12, 32768
    s_nop 0
    buffer_load_dwordx4 v2, s[48:51], s14 offen lds
    buffer_load_dwordx4 v3, s[48:51], s14 offen offset:1024 lds
    s_waitcnt vmcnt(12)
    s_barrier
    s_add_u32 m0, s13, 40960
k1_s17:
    s_cbranch_execz k1_ret
    s_add_u32 s14, s99, 0
    buffer_load_dwordx4 v10, s[52:55], s14 offen offset:0 lds
    buffer_load_dwordx4 v11, s[52:55], s14 offen offset:1024 lds
    buffer_load_dwordx4 v12, s[52:55], s14 offen offset:2048 lds
    buffer_load_dwordx4 v13, s[52:55], s14 offen offset:3072 lds
    s_add_u32 m0, s13, 57344
    s_add_u32 s14, s98, 1024
    buffer_load_dwordx4 v10, s[52:55], s14 offen offset:0 lds
    buffer_load_dwordx4 v11, s[52:55], s14 offen offset:1024 lds
    buffer_load_dwordx4 v12, s[52:55], s14 offen offset:2048 lds
    buffer_load_dwordx4 v13, s[52:55], s14 offen offset:3072 lds
    s_waitcnt vmcnt(12)
    s_barrier
    s_add_u32 m0, s13, 73728
    s_add_u32 s14, s99, 1024
    buffer_load_dwordx4 v10, s[52:55], s14 offen offset:0 lds
    buffer_load_dwordx4 v11, s[52:55], s14 offen offset:1024 lds
    buffer_load_dwordx4 v12, s[52:55], s14 offen offset:2048 lds
    buffer_load_dwordx4 v13, s[52:55], s14 offen offset:3072 lds
    s_add_u32 m0, s13, 90112
    s_add_u32 s14, s98, 2048
    buffer_load_dwordx4 v10, s[52:55], s14 offen offset:0 lds
    buffer_load_dwordx4 v11, s[52:55], s14 offen offset:1024 lds
    buffer_load_dwordx4 v12, s[52:55], s14 offen offset:2048 lds
    buffer_load_dwordx4 v13, s[52:55], s14 offen offset:3072 lds
    s_waitcnt vmcnt(12)
    s_barrier
    s_add_u32 m0, s13, 106496
    s_add_u32 s14, s99, 2048
    buffer_load_dwordx4 v10, s[52:55], s14 offen offset:0 lds
    buffer_load_dwordx4 v11, s[52:55], s14 offen offset:1024 lds
    buffer_load_dwordx4 v12, s[52:55], s14 offen offset:2048 lds
    buffer_load_dwordx4 v13, s[52:55], s14 offen offset:3072 lds
    s_waitcnt vmcnt(8)
    s_barrier
k1_s18:
    s_cbranch_execz k1_ret
    s_waitcnt vmcnt(4)
    s_barrier
    s_waitcnt vmcnt(0)
    s_barrier
    s_bfe_u32 s92, s2, 196611
    s_and_b32 s93, s94, 3
    s_lshl2_add_u32 s92, s92, s93
    s_mov_b64 exec, 0
    s_cmp_eq_u32 s92, 0
    s_cbranch_scc1 k2_s0
    s_cmp_eq_u32 s92, 1
    s_cbranch_scc1 k2_s1
    s_cmp_eq_u32 s92, 2
    s_cbranch_scc1 k2_s2
    s_cmp_eq_u32 s92, 3
    s_cbranch_scc1 k2_s3
    s_cmp_eq_u32 s92, 4
    s_cbranch_scc1 k2_s4
    s_cmp_eq_u32 s92, 5
    s_cbranch_scc1 k2_s5
    s_cmp_eq_u32 s92, 6
    s_cbranch_scc1 k2_s6
    s_cmp_eq_u32 s92, 7
    s_cbranch_scc1 k2_s7
    s_cmp_eq_u32 s92, 8
    s_cbranch_scc1 k2_s8
    s_cmp_eq_u32 s92, 9
    s_cbranch_scc1 k2_s9
    s_cmp_eq_u32 s92, 10
    s_cbranch_scc1 k2_s10
    s_cmp_eq_u32 s92, 11
    s_cbranch_scc1 k2_s11
    s_endpgm
    s_endpgm
    .p2align 7
k1_kgen:
    s_setprio 3
    s_lshl_b32 s6, s4, 6
    s_lshl_b32 s7, s5, 1
    s_add_u32 s6, s6, s7
    s_lshr_b32 s7, s15, 1
    s_add_u32 s6, s6, s7
    s_lshl_b32 s8, s6, 8
    s_and_b32 s9, s15, 1
    s_lshl_b32 s9, s9, 7
    s_add_u32 s8, s8, s9
    s_lshl_b32 s9, s6, 1
    v_lshl_add_u32 v1, v0, 1, s8
    v_mov_b32 v10, s9
    s_lshl_b32 s12, s7, 12
    s_add_u32 s12, s12, 0
    v_lshl_add_u32 v67, v0, 4, s12
    v_mov_b32 v2, 0
    v_mov_b32 v3, 0
    v_mov_b32 v4, 0
    v_mov_b32 v5, 0
    v_mov_b32 v6, 0
    v_mov_b32 v7, 0
    v_mov_b32 v8, 0
    v_mov_b32 v9, 0
    ds_write_b32 v67, v2 offset:3072
    s_waitcnt lgkmcnt(0)
    global_load_short_d16_hi v8, v10, s[30:31]
    global_load_short_d16_hi v2, v1, s[18:19]
    global_load_short_d16_hi v3, v1, s[20:21]
    global_load_short_d16_hi v4, v1, s[22:23]
    global_load_short_d16_hi v5, v1, s[24:25]
    global_load_short_d16_hi v6, v1, s[26:27]
    global_load_short_d16_hi v7, v1, s[28:29]
    global_load_short_d16_hi v9, v10, s[32:33]
    s_mul_i32 s11, s6, 1536
    s_add_u32 s11, s11, 8912896
    s_mov_b32 s13, 0x3fb8aa3b
    s_mov_b32 s14, 0x3e22f983
    v_and_b32 v20, 15, v0
    v_lshrrev_b32 v21, 4, v0
    v_and_b32 v22, 1, v0
    v_cvt_f32_u32 v64, v20
    v_mul_f32 v65, 16.0, v64
k1_s19:
    s_cbranch_execz k1_ret
    v_and_b32 v23, 3, v0
    v_lshlrev_b32 v23, 2, v23
    v_lshrrev_b32 v24, 2, v20
    v_lshl_add_u32 v23, v24, 8, v23
    v_add_u32 v23, 512, v23
    v_lshlrev_b32 v24, 3, v22
    v_lshrrev_b32 v25, 1, v20
    v_lshl_add_u32 v24, v25, 8, v24
    v_cmp_gt_u32 vcc, 8, v20
    v_sub_u32 v72, 63, v0
    v_cndmask_b32 v23, v24, v23, vcc
    v_cvt_f32_u32 v66, v23
    v_lshlrev_b32 v72, 2, v72
    v_lshlrev_b32 v69, 5, v20
    v_lshl_add_u32 v69, v21, 3, v69
    v_lshrrev_b32 v24, 5, v0
    v_sub_u32 v25, 3, v24
    v_lshlrev_b32 v25, v25, v20
    v_lshl_add_u32 v70, v21, 7, v25
    v_mul_u32_u24 v24, 60, v24
    v_add3_u32 v71, v24, v70, 4
    v_lshrrev_b32 v68, 1, v69
    v_cmp_eq_u32 vcc, 0, v0
    s_mov_b32 s44, s40
    s_and_b32 s45, s41, 0xffff
    s_mov_b32 s46, 0x1000000
    s_mov_b32 s47, 0x00020000
    s_setprio 2
    s_waitcnt vmcnt(7)
    v_mul_f32 v8, s13, v8
    v_exp_f32 v8, v8
    s_nop 0
    v_cvt_pk_bf16_f32 v8, v8, v8
    v_lshlrev_b32 v8, 16, v8
    s_waitcnt vmcnt(5)
    v_mul_f32 v2, v8, v2
    v_mul_f32 v3, v8, v3
    v_mul_f32 v12, s13, v2
    v_mul_f32 v13, s14, v3
    v_rndne_f32 v3, v13
    v_sub_f32 v13, v13, v3
    v_mul_f32 v20, 0x43800000, v12
    v_mul_f32 v21, 0x43800000, v13
    v_mul_f32 v22, 0x45000000, v12
    v_mul_f32 v23, 0x45000000, v13
    v_exp_f32 v20, v20
    v_exp_f32 v22, v22
    v_fract_f32 v23, v23
    v_cos_f32 v16, v21
k1_s20:
    s_cbranch_execz k1_ret
    v_sin_f32 v17, v21
    v_cos_f32 v18, v23
    v_sin_f32 v19, v23
    s_waitcnt vmcnt(1)
    v_mul_f32 v4, v8, v4
    v_mul_f32 v5, v8, v5
    v_mul_f32 v14, v6, v4
    v_mul_f32_e64 v15, -v6, v5
    v_fma_f32 v14, -v7, v5, v14
    v_fma_f32 v15, -v7, v4, v15
    v_mul_f32 v16, v20, v16
    v_mul_f32 v17, v20, v17
    v_mul_f32 v18, v14, v18
    v_fmac_f32 v18, v15, v19
    v_mul_f32 v18, v22, v18
    v_mul_f32_dpp v48, v12, v65 row_newbcast:0 row_mask:0xf bank_mask:0xf
    v_mul_f32_dpp v52, v13, v65 row_newbcast:0 row_mask:0xf bank_mask:0xf
    v_mul_f32_dpp v49, v12, v65 row_newbcast:1 row_mask:0xf bank_mask:0xf
    v_mul_f32_dpp v53, v13, v65 row_newbcast:1 row_mask:0xf bank_mask:0xf
    v_mul_f32_dpp v50, v12, v65 row_newbcast:2 row_mask:0xf bank_mask:0xf
    v_mul_f32_dpp v54, v13, v65 row_newbcast:2 row_mask:0xf bank_mask:0xf
    v_mul_f32_dpp v51, v12, v65 row_newbcast:3 row_mask:0xf bank_mask:0xf
    v_mul_f32_dpp v55, v13, v65 row_newbcast:3 row_mask:0xf bank_mask:0xf
    v_add_f32_dpp v18, v18, v18 row_ror:1 row_mask:0xf bank_mask:0xf
    v_exp_f32 v48, v48
    v_exp_f32 v49, v49
    v_exp_f32 v50, v50
    v_exp_f32 v51, v51
    v_cos_f32 v56, v52
    v_sin_f32 v60, v52
    v_cos_f32 v57, v53
    v_sin_f32 v61, v53
    v_cos_f32 v58, v54
    v_sin_f32 v62, v54
    v_cos_f32 v59, v55
    v_sin_f32 v63, v55
    v_mul_f32_dpp v76, v14, v48 row_newbcast:0 row_mask:0xf bank_mask:0xf
    v_mul_f32_dpp v80, v15, v48 row_newbcast:0 row_mask:0xf bank_mask:0xf
    v_mul_f32_dpp v77, v14, v49 row_newbcast:1 row_mask:0xf bank_mask:0xf
    v_mul_f32_dpp v81, v15, v49 row_newbcast:1 row_mask:0xf bank_mask:0xf
    v_mul_f32_dpp v78, v14, v50 row_newbcast:2 row_mask:0xf bank_mask:0xf
    v_mul_f32_dpp v82, v15, v50 row_newbcast:2 row_mask:0xf bank_mask:0xf
    v_mul_f32_dpp v79, v14, v51 row_newbcast:3 row_mask:0xf bank_mask:0xf
    v_mul_f32_dpp v83, v15, v51 row_newbcast:3 row_mask:0xf bank_mask:0xf
k1_s21:
    s_cbranch_execz k1_ret
    v_mul_f32 v48, v76, v56
    v_mul_f32 v52, v80, v56
    v_mul_f32 v49, v77, v57
    v_mul_f32 v53, v81, v57
    v_mul_f32 v50, v78, v58
    v_mul_f32 v54, v82, v58
    v_mul_f32 v51, v79, v59
    v_mul_f32 v55, v83, v59
    v_fmac_f32 v48, v80, v60
    v_fma_f32 v52, -v76, v60, v52
    v_fmac_f32 v49, v81, v61
    v_fma_f32 v53, -v77, v61, v53
    v_fmac_f32 v50, v82, v62
    v_fma_f32 v54, -v78, v62, v54
    v_fmac_f32 v51, v83, v63
    v_fma_f32 v55, -v79, v63, v55
    v_cvt_pk_bf16_f32 v44, v48, v52
    v_cvt_pk_bf16_f32 v45, v49, v53
    v_cvt_pk_bf16_f32 v46, v50, v54
    v_cvt_pk_bf16_f32 v47, v51, v55
    v_mul_f32_dpp v48, v12, v66 row_newbcast:0 row_mask:0xf bank_mask:0xf
    v_mul_f32_dpp v52, v13, v66 row_newbcast:0 row_mask:0xf bank_mask:0xf
    v_mul_f32_dpp v49, v12, v66 row_newbcast:1 row_mask:0xf bank_mask:0xf
    v_mul_f32_dpp v53, v13, v66 row_newbcast:1 row_mask:0xf bank_mask:0xf
    v_mul_f32_dpp v50, v12, v66 row_newbcast:2 row_mask:0xf bank_mask:0xf
    v_mul_f32_dpp v54, v13, v66 row_newbcast:2 row_mask:0xf bank_mask:0xf
    v_mul_f32_dpp v51, v12, v66 row_newbcast:3 row_mask:0xf bank_mask:0xf
    v_mul_f32_dpp v55, v13, v66 row_newbcast:3 row_mask:0xf bank_mask:0xf
    v_add_f32_dpp v18, v18, v18 row_ror:2 row_mask:0xf bank_mask:0xf
    v_exp_f32 v48, v48
    v_fract_f32 v52, v52
    v_exp_f32 v49, v49
    v_fract_f32 v53, v53
    v_exp_f32 v50, v50
    v_fract_f32 v54, v54
    v_exp_f32 v51, v51
    v_fract_f32 v55, v55
    v_cos_f32 v56, v52
    v_sin_f32 v60, v52
    v_cos_f32 v57, v53
    v_sin_f32 v61, v53
    v_cos_f32 v58, v54
    v_sin_f32 v62, v54
    v_cos_f32 v59, v55
    v_sin_f32 v63, v55
    v_mul_f32 v56, v48, v56
k1_s22:
    s_cbranch_execz k1_ret
    v_mul_f32 v60, v48, v60
    v_mul_f32 v57, v49, v57
    v_mul_f32 v61, v49, v61
    v_mul_f32 v58, v50, v58
    v_mul_f32 v62, v50, v62
    v_mul_f32 v59, v51, v59
    v_mul_f32 v63, v51, v63
    v_cvt_pk_bf16_f32 v40, v56, v60
    v_cvt_pk_bf16_f32 v41, v57, v61
    v_cvt_pk_bf16_f32 v42, v58, v62
    v_cvt_pk_bf16_f32 v43, v59, v63
    v_mul_f32_dpp v48, v12, v64 row_newbcast:0 row_mask:0xf bank_mask:0xf
    v_mul_f32_dpp v52, v13, v64 row_newbcast:0 row_mask:0xf bank_mask:0xf
    v_mul_f32_dpp v49, v12, v64 row_newbcast:1 row_mask:0xf bank_mask:0xf
    v_mul_f32_dpp v53, v13, v64 row_newbcast:1 row_mask:0xf bank_mask:0xf
    v_mul_f32_dpp v50, v12, v64 row_newbcast:2 row_mask:0xf bank_mask:0xf
    v_mul_f32_dpp v54, v13, v64 row_newbcast:2 row_mask:0xf bank_mask:0xf
    v_mul_f32_dpp v51, v12, v64 row_newbcast:3 row_mask:0xf bank_mask:0xf
    v_mul_f32_dpp v55, v13, v64 row_newbcast:3 row_mask:0xf bank_mask:0xf
    v_add_f32_dpp v18, v18, v18 row_ror:4 row_mask:0xf bank_mask:0xf
    v_exp_f32 v48, v48
    v_exp_f32 v49, v49
    v_exp_f32 v50, v50
    v_exp_f32 v51, v51
    v_cos_f32 v56, v52
    v_sin_f32 v60, v52
    v_cos_f32 v57, v53
    v_sin_f32 v61, v53
    v_cos_f32 v58, v54
    v_sin_f32 v62, v54
    v_cos_f32 v59, v55
    v_sin_f32 v63, v55
    v_mfma_f32_16x16x32_bf16 v[28:31], v[40:43], v[44:47], 0
    s_barrier
    v_mul_f32 v56, v48, v56
    v_mul_f32 v60, v48, v60
    v_mul_f32 v57, v49, v57
    v_mul_f32 v61, v49, v61
    v_mul_f32 v58, v50, v58
    v_mul_f32 v62, v50, v62
    v_mul_f32 v59, v51, v59
    v_mul_f32 v63, v51, v63
    v_cvt_pk_bf16_f32 v32, v56, v60
    v_cvt_pk_bf16_f32 v33, v57, v61
    v_cvt_pk_bf16_f32 v34, v58, v62
    v_cvt_pk_bf16_f32 v35, v59, v63
k1_s23:
    s_cbranch_execz k1_ret
    v_mul_f32_dpp v48, v16, v56 row_newbcast:0 row_mask:0xf bank_mask:0xf
    v_mul_f32_dpp v52, v17, v56 row_newbcast:0 row_mask:0xf bank_mask:0xf
    v_mul_f32_dpp v49, v16, v57 row_newbcast:1 row_mask:0xf bank_mask:0xf
    v_mul_f32_dpp v53, v17, v57 row_newbcast:1 row_mask:0xf bank_mask:0xf
    v_mul_f32_dpp v50, v16, v58 row_newbcast:2 row_mask:0xf bank_mask:0xf
    v_mul_f32_dpp v54, v17, v58 row_newbcast:2 row_mask:0xf bank_mask:0xf
    v_mul_f32_dpp v51, v16, v59 row_newbcast:3 row_mask:0xf bank_mask:0xf
    v_mul_f32_dpp v55, v17, v59 row_newbcast:3 row_mask:0xf bank_mask:0xf
    v_mfma_f32_16x16x32_bf16 v[20:23], v[32:35], v[44:47], 0
    v_fmac_f32_dpp v48, -v17, v60 row_newbcast:0 row_mask:0xf bank_mask:0xf
    v_fmac_f32_dpp v52, v16, v60 row_newbcast:0 row_mask:0xf bank_mask:0xf
    v_fmac_f32_dpp v49, -v17, v61 row_newbcast:1 row_mask:0xf bank_mask:0xf
    v_fmac_f32_dpp v53, v16, v61 row_newbcast:1 row_mask:0xf bank_mask:0xf
    v_fmac_f32_dpp v50, -v17, v62 row_newbcast:2 row_mask:0xf bank_mask:0xf
    v_fmac_f32_dpp v54, v16, v62 row_newbcast:2 row_mask:0xf bank_mask:0xf
    v_fmac_f32_dpp v51, -v17, v63 row_newbcast:3 row_mask:0xf bank_mask:0xf
    v_fmac_f32_dpp v55, v16, v63 row_newbcast:3 row_mask:0xf bank_mask:0xf
    v_cvt_pk_bf16_f32 v36, v48, v52
    v_cvt_pk_bf16_f32 v37, v49, v53
    v_cvt_pk_bf16_f32 v38, v50, v54
    v_cvt_pk_bf16_f32 v39, v51, v55
    s_nop 1
    v_mfma_f32_16x16x32_bf16 v[24:27], v[36:39], v[44:47], 0
    v_mul_f32_dpp v48, v12, v65 row_newbcast:4 row_mask:0xf bank_mask:0xf
    v_mul_f32_dpp v52, v13, v65 row_newbcast:4 row_mask:0xf bank_mask:0xf
    v_mul_f32_dpp v49, v12, v65 row_newbcast:5 row_mask:0xf bank_mask:0xf
    v_mul_f32_dpp v53, v13, v65 row_newbcast:5 row_mask:0xf bank_mask:0xf
    v_mul_f32_dpp v50, v12, v65 row_newbcast:6 row_mask:0xf bank_mask:0xf
    v_mul_f32_dpp v54, v13, v65 row_newbcast:6 row_mask:0xf bank_mask:0xf
    v_mul_f32_dpp v51, v12, v65 row_newbcast:7 row_mask:0xf bank_mask:0xf
    v_mul_f32_dpp v55, v13, v65 row_newbcast:7 row_mask:0xf bank_mask:0xf
    v_add_f32_dpp v18, v18, v18 row_ror:8 row_mask:0xf bank_mask:0xf
k1_s24:
    s_cbranch_execz k1_ret
    v_exp_f32 v48, v48
    v_exp_f32 v49, v49
    v_exp_f32 v50, v50
    v_exp_f32 v51, v51
    v_cos_f32 v56, v52
    v_sin_f32 v60, v52
    v_cos_f32 v57, v53
    v_sin_f32 v61, v53
    v_cos_f32 v58, v54
    v_sin_f32 v62, v54
    v_cos_f32 v59, v55
    v_sin_f32 v63, v55
    v_mul_f32_dpp v76, v14, v48 row_newbcast:4 row_mask:0xf bank_mask:0xf
    v_mul_f32_dpp v80, v15, v48 row_newbcast:4 row_mask:0xf bank_mask:0xf
    v_mul_f32_dpp v77, v14, v49 row_newbcast:5 row_mask:0xf bank_mask:0xf
    v_mul_f32_dpp v81, v15, v49 row_newbcast:5 row_mask:0xf bank_mask:0xf
    v_mul_f32_dpp v78, v14, v50 row_newbcast:6 row_mask:0xf bank_mask:0xf
    v_mul_f32_dpp v82, v15, v50 row_newbcast:6 row_mask:0xf bank_mask:0xf
    v_mul_f32_dpp v79, v14, v51 row_newbcast:7 row_mask:0xf bank_mask:0xf
    v_mul_f32_dpp v83, v15, v51 row_newbcast:7 row_mask:0xf bank_mask:0xf
    v_mul_f32 v48, v76, v56
    v_mul_f32 v52, v80, v56
    v_mul_f32 v49, v77, v57
    v_mul_f32 v53, v81, v57
    v_mul_f32 v50, v78, v58
    v_mul_f32 v54, v82, v58
    v_mul_f32 v51, v79, v59
    v_mul_f32 v55, v83, v59
    v_fmac_f32 v48, v80, v60
    v_fma_f32 v52, -v76, v60, v52
    v_fmac_f32 v49, v81, v61
    s_barrier
    v_fma_f32 v53, -v77, v61, v53
    v_fmac_f32 v50, v82, v62
    v_fma_f32 v54, -v78, v62, v54
    v_fmac_f32 v51, v83, v63
    v_fma_f32 v55, -v79, v63, v55
    v_cvt_pk_bf16_f32 v44, v48, v52
    v_cvt_pk_bf16_f32 v45, v49, v53
    v_cvt_pk_bf16_f32 v46, v50, v54
    v_cvt_pk_bf16_f32 v47, v51, v55
    v_mul_f32_dpp v48, v12, v66 row_newbcast:4 row_mask:0xf bank_mask:0xf
    v_mul_f32_dpp v52, v13, v66 row_newbcast:4 row_mask:0xf bank_mask:0xf
    v_mul_f32_dpp v49, v12, v66 row_newbcast:5 row_mask:0xf bank_mask:0xf
k1_s25:
    s_cbranch_execz k1_ret
    v_mul_f32_dpp v53, v13, v66 row_newbcast:5 row_mask:0xf bank_mask:0xf
    v_mul_f32_dpp v50, v12, v66 row_newbcast:6 row_mask:0xf bank_mask:0xf
    v_mul_f32_dpp v54, v13, v66 row_newbcast:6 row_mask:0xf bank_mask:0xf
    v_mul_f32_dpp v51, v12, v66 row_newbcast:7 row_mask:0xf bank_mask:0xf
    v_mul_f32_dpp v55, v13, v66 row_newbcast:7 row_mask:0xf bank_mask:0xf
    v_add_f32_dpp v18, v18, v18 row_bcast:15 row_mask:0xa bank_mask:0xf
    v_exp_f32 v48, v48
    v_fract_f32 v52, v52
    v_exp_f32 v49, v49
    v_fract_f32 v53, v53
    v_exp_f32 v50, v50
    v_fract_f32 v54, v54
    v_exp_f32 v51, v51
    v_fract_f32 v55, v55
    v_cos_f32 v56, v52
    v_sin_f32 v60, v52
    v_cos_f32 v57, v53
    v_sin_f32 v61, v53
    v_cos_f32 v58, v54
    v_sin_f32 v62, v54
    v_cos_f32 v59, v55
    v_sin_f32 v63, v55
    v_mul_f32 v56, v48, v56
    v_mul_f32 v60, v48, v60
    v_mul_f32 v57, v49, v57
    v_mul_f32 v61, v49, v61
    v_mul_f32 v58, v50, v58
    v_mul_f32 v62, v50, v62
    v_mul_f32 v59, v51, v59
    v_mul_f32 v63, v51, v63
    v_cvt_pk_bf16_f32 v40, v56, v60
    v_cvt_pk_bf16_f32 v41, v57, v61
    v_cvt_pk_bf16_f32 v42, v58, v62
    v_cvt_pk_bf16_f32 v43, v59, v63
    v_mul_f32_dpp v48, v12, v64 row_newbcast:4 row_mask:0xf bank_mask:0xf
    v_mul_f32_dpp v52, v13, v64 row_newbcast:4 row_mask:0xf bank_mask:0xf
    v_mul_f32_dpp v49, v12, v64 row_newbcast:5 row_mask:0xf bank_mask:0xf
    v_mul_f32_dpp v53, v13, v64 row_newbcast:5 row_mask:0xf bank_mask:0xf
    v_mul_f32_dpp v50, v12, v64 row_newbcast:6 row_mask:0xf bank_mask:0xf
    v_mul_f32_dpp v54, v13, v64 row_newbcast:6 row_mask:0xf bank_mask:0xf
    v_mul_f32_dpp v51, v12, v64 row_newbcast:7 row_mask:0xf bank_mask:0xf
    v_mul_f32_dpp v55, v13, v64 row_newbcast:7 row_mask:0xf bank_mask:0xf
    v_add_f32_dpp v18, v18, v18 row_bcast:31 row_mask:0xc bank_mask:0xf
    v_exp_f32 v48, v48
k1_s26:
    s_cbranch_execz k1_ret
    v_exp_f32 v49, v49
    v_exp_f32 v50, v50
    v_exp_f32 v51, v51
    v_cos_f32 v56, v52
    v_sin_f32 v60, v52
    v_cos_f32 v57, v53
    v_sin_f32 v61, v53
    v_cos_f32 v58, v54
    v_sin_f32 v62, v54
    v_cos_f32 v59, v55
    v_sin_f32 v63, v55
    v_mfma_f32_16x16x32_bf16 v[28:31], v[40:43], v[44:47], v[28:31]
    s_barrier
    v_mul_f32 v56, v48, v56
    v_mul_f32 v60, v48, v60
    v_mul_f32 v57, v49, v57
    v_mul_f32 v61, v49, v61
    v_mul_f32 v58, v50, v58
    v_mul_f32 v62, v50, v62
    v_mul_f32 v59, v51, v59
    v_mul_f32 v63, v51, v63
    v_cvt_pk_bf16_f32 v32, v56, v60
    v_cvt_pk_bf16_f32 v33, v57, v61
    v_cvt_pk_bf16_f32 v34, v58, v62
    v_cvt_pk_bf16_f32 v35, v59, v63
    v_mul_f32_dpp v48, v16, v56 row_newbcast:4 row_mask:0xf bank_mask:0xf
    v_mul_f32_dpp v52, v17, v56 row_newbcast:4 row_mask:0xf bank_mask:0xf
    v_mul_f32_dpp v49, v16, v57 row_newbcast:5 row_mask:0xf bank_mask:0xf
    v_mul_f32_dpp v53, v17, v57 row_newbcast:5 row_mask:0xf bank_mask:0xf
    v_mul_f32_dpp v50, v16, v58 row_newbcast:6 row_mask:0xf bank_mask:0xf
    v_mul_f32_dpp v54, v17, v58 row_newbcast:6 row_mask:0xf bank_mask:0xf
    v_mul_f32_dpp v51, v16, v59 row_newbcast:7 row_mask:0xf bank_mask:0xf
    v_mul_f32_dpp v55, v17, v59 row_newbcast:7 row_mask:0xf bank_mask:0xf
    v_mfma_f32_16x16x32_bf16 v[20:23], v[32:35], v[44:47], v[20:23]
    v_fmac_f32_dpp v48, -v17, v60 row_newbcast:4 row_mask:0xf bank_mask:0xf
    v_fmac_f32_dpp v52, v16, v60 row_newbcast:4 row_mask:0xf bank_mask:0xf
    v_fmac_f32_dpp v49, -v17, v61 row_newbcast:5 row_mask:0xf bank_mask:0xf
    v_fmac_f32_dpp v53, v16, v61 row_newbcast:5 row_mask:0xf bank_mask:0xf
    v_fmac_f32_dpp v50, -v17, v62 row_newbcast:6 row_mask:0xf bank_mask:0xf
    v_fmac_f32_dpp v54, v16, v62 row_newbcast:6 row_mask:0xf bank_mask:0xf
    v_fmac_f32_dpp v51, -v17, v63 row_newbcast:7 row_mask:0xf bank_mask:0xf
    v_fmac_f32_dpp v55, v16, v63 row_newbcast:7 row_mask:0xf bank_mask:0xf
k1_s27:
    s_cbranch_execz k1_ret
    v_cvt_pk_bf16_f32 v36, v48, v52
    v_cvt_pk_bf16_f32 v37, v49, v53
    v_cvt_pk_bf16_f32 v38, v50, v54
    v_cvt_pk_bf16_f32 v39, v51, v55
    s_nop 1
    v_mfma_f32_16x16x32_bf16 v[24:27], v[36:39], v[44:47], v[24:27]
    v_mul_f32_dpp v48, v12, v65 row_newbcast:8 row_mask:0xf bank_mask:0xf
    v_mul_f32_dpp v52, v13, v65 row_newbcast:8 row_mask:0xf bank_mask:0xf
    v_mul_f32_dpp v49, v12, v65 row_newbcast:9 row_mask:0xf bank_mask:0xf
    v_mul_f32_dpp v53, v13, v65 row_newbcast:9 row_mask:0xf bank_mask:0xf
    v_mul_f32_dpp v50, v12, v65 row_newbcast:10 row_mask:0xf bank_mask:0xf
    v_mul_f32_dpp v54, v13, v65 row_newbcast:10 row_mask:0xf bank_mask:0xf
    v_mul_f32_dpp v51, v12, v65 row_newbcast:11 row_mask:0xf bank_mask:0xf
    v_mul_f32_dpp v55, v13, v65 row_newbcast:11 row_mask:0xf bank_mask:0xf
    v_exp_f32 v48, v48
    v_exp_f32 v49, v49
    v_exp_f32 v50, v50
    v_exp_f32 v51, v51
    v_cos_f32 v56, v52
    v_sin_f32 v60, v52
    v_cos_f32 v57, v53
    v_sin_f32 v61, v53
    v_cos_f32 v58, v54
    v_sin_f32 v62, v54
    v_cos_f32 v59, v55
    v_sin_f32 v63, v55
    v_mul_f32_dpp v76, v14, v48 row_newbcast:8 row_mask:0xf bank_mask:0xf
    v_mul_f32_dpp v80, v15, v48 row_newbcast:8 row_mask:0xf bank_mask:0xf
    v_mul_f32_dpp v77, v14, v49 row_newbcast:9 row_mask:0xf bank_mask:0xf
    v_mul_f32_dpp v81, v15, v49 row_newbcast:9 row_mask:0xf bank_mask:0xf
    v_mul_f32_dpp v78, v14, v50 row_newbcast:10 row_mask:0xf bank_mask:0xf
    v_mul_f32_dpp v82, v15, v50 row_newbcast:10 row_mask:0xf bank_mask:0xf
    v_mul_f32_dpp v79, v14, v51 row_newbcast:11 row_mask:0xf bank_mask:0xf
    v_mul_f32_dpp v83, v15, v51 row_newbcast:11 row_mask:0xf bank_mask:0xf
    v_mul_f32 v48, v76, v56
    v_mul_f32 v52, v80, v56
    v_mul_f32 v49, v77, v57
    v_mul_f32 v53, v81, v57
    v_mul_f32 v50, v78, v58
    v_mul_f32 v54, v82, v58
    v_mul_f32 v51, v79, v59
    v_mul_f32 v55, v83, v59
k1_s28:
    s_cbranch_execz k1_ret
    v_fmac_f32 v48, v80, v60
    v_fma_f32 v52, -v76, v60, v52
    v_fmac_f32 v49, v81, v61
    v_fma_f32 v53, -v77, v61, v53
    v_fmac_f32 v50, v82, v62
    s_barrier
    v_fma_f32 v54, -v78, v62, v54
    v_fmac_f32 v51, v83, v63
    v_fma_f32 v55, -v79, v63, v55
    v_cvt_pk_bf16_f32 v44, v48, v52
    v_cvt_pk_bf16_f32 v45, v49, v53
    v_cvt_pk_bf16_f32 v46, v50, v54
    v_cvt_pk_bf16_f32 v47, v51, v55
    v_mul_f32_dpp v48, v12, v66 row_newbcast:8 row_mask:0xf bank_mask:0xf
    v_mul_f32_dpp v52, v13, v66 row_newbcast:8 row_mask:0xf bank_mask:0xf
    v_mul_f32_dpp v49, v12, v66 row_newbcast:9 row_mask:0xf bank_mask:0xf
    v_mul_f32_dpp v53, v13, v66 row_newbcast:9 row_mask:0xf bank_mask:0xf
    v_mul_f32_dpp v50, v12, v66 row_newbcast:10 row_mask:0xf bank_mask:0xf
    v_mul_f32_dpp v54, v13, v66 row_newbcast:10 row_mask:0xf bank_mask:0xf
    v_mul_f32_dpp v51, v12, v66 row_newbcast:11 row_mask:0xf bank_mask:0xf
    v_mul_f32_dpp v55, v13, v66 row_newbcast:11 row_mask:0xf bank_mask:0xf
    v_exp_f32 v48, v48
    v_fract_f32 v52, v52
    v_exp_f32 v49, v49
    v_fract_f32 v53, v53
    v_exp_f32 v50, v50
    v_fract_f32 v54, v54
    v_exp_f32 v51, v51
    v_fract_f32 v55, v55
    v_cos_f32 v56, v52
    v_sin_f32 v60, v52
    v_cos_f32 v57, v53
    v_sin_f32 v61, v53
    v_cos_f32 v58, v54
    v_sin_f32 v62, v54
    v_cos_f32 v59, v55
    v_sin_f32 v63, v55
    v_mul_f32 v56, v48, v56
    v_mul_f32 v60, v48, v60
    v_mul_f32 v57, v49, v57
    v_mul_f32 v61, v49, v61
    v_mul_f32 v58, v50, v58
    v_mul_f32 v62, v50, v62
    v_mul_f32 v59, v51, v59
    v_mul_f32 v63, v51, v63
    v_cvt_pk_bf16_f32 v40, v56, v60
k1_s29:
    s_cbranch_execz k1_ret
    v_cvt_pk_bf16_f32 v41, v57, v61
    v_cvt_pk_bf16_f32 v42, v58, v62
    v_cvt_pk_bf16_f32 v43, v59, v63
    v_mul_f32_dpp v48, v12, v64 row_newbcast:8 row_mask:0xf bank_mask:0xf
    v_mul_f32_dpp v52, v13, v64 row_newbcast:8 row_mask:0xf bank_mask:0xf
    v_mul_f32_dpp v49, v12, v64 row_newbcast:9 row_mask:0xf bank_mask:0xf
    v_mul_f32_dpp v53, v13, v64 row_newbcast:9 row_mask:0xf bank_mask:0xf
    v_mul_f32_dpp v50, v12, v64 row_newbcast:10 row_mask:0xf bank_mask:0xf
    v_mul_f32_dpp v54, v13, v64 row_newbcast:10 row_mask:0xf bank_mask:0xf
    v_mul_f32_dpp v51, v12, v64 row_newbcast:11 row_mask:0xf bank_mask:0xf
    v_mul_f32_dpp v55, v13, v64 row_newbcast:11 row_mask:0xf bank_mask:0xf
    v_exp_f32 v48, v48
    v_exp_f32 v49, v49
    v_exp_f32 v50, v50
    v_exp_f32 v51, v51
    v_cos_f32 v56, v52
    v_sin_f32 v60, v52
    v_cos_f32 v57, v53
    v_sin_f32 v61, v53
    v_cos_f32 v58, v54
    v_sin_f32 v62, v54
    v_cos_f32 v59, v55
    v_sin_f32 v63, v55
    v_mfma_f32_16x16x32_bf16 v[28:31], v[40:43], v[44:47], v[28:31]
    v_mul_f32 v56, v48, v56
    v_mul_f32 v60, v48, v60
    v_mul_f32 v57, v49, v57
    v_mul_f32 v61, v49, v61
    s_barrier
    v_mul_f32 v58, v50, v58
    v_mul_f32 v62, v50, v62
    v_mul_f32 v59, v51, v59
    v_mul_f32 v63, v51, v63
    v_cvt_pk_bf16_f32 v32, v56, v60
    v_cvt_pk_bf16_f32 v33, v57, v61
    v_cvt_pk_bf16_f32 v34, v58, v62
    v_cvt_pk_bf16_f32 v35, v59, v63
    v_mul_f32_dpp v48, v16, v56 row_newbcast:8 row_mask:0xf bank_mask:0xf
    v_mul_f32_dpp v52, v17, v56 row_newbcast:8 row_mask:0xf bank_mask:0xf
    v_mul_f32_dpp v49, v16, v57 row_newbcast:9 row_mask:0xf bank_mask:0xf
    v_mul_f32_dpp v53, v17, v57 row_newbcast:9 row_mask:0xf bank_mask:0xf
    v_mul_f32_dpp v50, v16, v58 row_newbcast:10 row_mask:0xf bank_mask:0xf
k1_s30:
    s_cbranch_execz k1_ret
    v_mul_f32_dpp v54, v17, v58 row_newbcast:10 row_mask:0xf bank_mask:0xf
    v_mul_f32_dpp v51, v16, v59 row_newbcast:11 row_mask:0xf bank_mask:0xf
    v_mul_f32_dpp v55, v17, v59 row_newbcast:11 row_mask:0xf bank_mask:0xf
    v_mfma_f32_16x16x32_bf16 v[20:23], v[32:35], v[44:47], v[20:23]
    v_fmac_f32_dpp v48, -v17, v60 row_newbcast:8 row_mask:0xf bank_mask:0xf
    v_fmac_f32_dpp v52, v16, v60 row_newbcast:8 row_mask:0xf bank_mask:0xf
    v_fmac_f32_dpp v49, -v17, v61 row_newbcast:9 row_mask:0xf bank_mask:0xf
    v_fmac_f32_dpp v53, v16, v61 row_newbcast:9 row_mask:0xf bank_mask:0xf
    v_fmac_f32_dpp v50, -v17, v62 row_newbcast:10 row_mask:0xf bank_mask:0xf
    v_fmac_f32_dpp v54, v16, v62 row_newbcast:10 row_mask:0xf bank_mask:0xf
    v_fmac_f32_dpp v51, -v17, v63 row_newbcast:11 row_mask:0xf bank_mask:0xf
    v_fmac_f32_dpp v55, v16, v63 row_newbcast:11 row_mask:0xf bank_mask:0xf
    v_cvt_pk_bf16_f32 v36, v48, v52
    v_cvt_pk_bf16_f32 v37, v49, v53
    v_cvt_pk_bf16_f32 v38, v50, v54
    v_cvt_pk_bf16_f32 v39, v51, v55
    s_nop 1
    v_mfma_f32_16x16x32_bf16 v[24:27], v[36:39], v[44:47], v[24:27]
    v_mul_f32_dpp v48, v12, v65 row_newbcast:12 row_mask:0xf bank_mask:0xf
    v_mul_f32_dpp v52, v13, v65 row_newbcast:12 row_mask:0xf bank_mask:0xf
    v_mul_f32_dpp v49, v12, v65 row_newbcast:13 row_mask:0xf bank_mask:0xf
    v_mul_f32_dpp v53, v13, v65 row_newbcast:13 row_mask:0xf bank_mask:0xf
    v_mul_f32_dpp v50, v12, v65 row_newbcast:14 row_mask:0xf bank_mask:0xf
    v_mul_f32_dpp v54, v13, v65 row_newbcast:14 row_mask:0xf bank_mask:0xf
    v_mul_f32_dpp v51, v12, v65 row_newbcast:15 row_mask:0xf bank_mask:0xf
    v_mul_f32_dpp v55, v13, v65 row_newbcast:15 row_mask:0xf bank_mask:0xf
    v_exp_f32 v48, v48
    v_exp_f32 v49, v49
    v_exp_f32 v50, v50
    v_exp_f32 v51, v51
    v_cos_f32 v56, v52
    v_sin_f32 v60, v52
    v_cos_f32 v57, v53
    v_sin_f32 v61, v53
    v_cos_f32 v58, v54
    v_sin_f32 v62, v54
    v_cos_f32 v59, v55
    v_sin_f32 v63, v55
k1_s31:
    s_cbranch_execz k1_ret
    v_mul_f32_dpp v76, v14, v48 row_newbcast:12 row_mask:0xf bank_mask:0xf
    v_mul_f32_dpp v80, v15, v48 row_newbcast:12 row_mask:0xf bank_mask:0xf
    v_mul_f32_dpp v77, v14, v49 row_newbcast:13 row_mask:0xf bank_mask:0xf
    v_mul_f32_dpp v81, v15, v49 row_newbcast:13 row_mask:0xf bank_mask:0xf
    v_mul_f32_dpp v78, v14, v50 row_newbcast:14 row_mask:0xf bank_mask:0xf
    v_mul_f32_dpp v82, v15, v50 row_newbcast:14 row_mask:0xf bank_mask:0xf
    v_mul_f32_dpp v79, v14, v51 row_newbcast:15 row_mask:0xf bank_mask:0xf
    v_mul_f32_dpp v83, v15, v51 row_newbcast:15 row_mask:0xf bank_mask:0xf
    v_mul_f32 v48, v76, v56
    v_mul_f32 v52, v80, v56
    v_mul_f32 v49, v77, v57
    v_mul_f32 v53, v81, v57
    v_mul_f32 v50, v78, v58
    v_mul_f32 v54, v82, v58
    v_mul_f32 v51, v79, v59
    v_mul_f32 v55, v83, v59
    v_fmac_f32 v48, v80, v60
    v_fma_f32 v52, -v76, v60, v52
    v_fmac_f32 v49, v81, v61
    v_fma_f32 v53, -v77, v61, v53
    v_fmac_f32 v50, v82, v62
    v_fma_f32 v54, -v78, v62, v54
    v_fmac_f32 v51, v83, v63
    v_fma_f32 v55, -v79, v63, v55
    s_barrier
    v_cvt_pk_bf16_f32 v44, v48, v52
    v_cvt_pk_bf16_f32 v45, v49, v53
    v_cvt_pk_bf16_f32 v46, v50, v54
    v_cvt_pk_bf16_f32 v47, v51, v55
    v_mul_f32_dpp v48, v12, v66 row_newbcast:12 row_mask:0xf bank_mask:0xf
    v_mul_f32_dpp v52, v13, v66 row_newbcast:12 row_mask:0xf bank_mask:0xf
    v_mul_f32_dpp v49, v12, v66 row_newbcast:13 row_mask:0xf bank_mask:0xf
    v_mul_f32_dpp v53, v13, v66 row_newbcast:13 row_mask:0xf bank_mask:0xf
    v_mul_f32_dpp v50, v12, v66 row_newbcast:14 row_mask:0xf bank_mask:0xf
    v_mul_f32_dpp v54, v13, v66 row_newbcast:14 row_mask:0xf bank_mask:0xf
    v_mul_f32_dpp v51, v12, v66 row_newbcast:15 row_mask:0xf bank_mask:0xf
    v_mul_f32_dpp v55, v13, v66 row_newbcast:15 row_mask:0xf bank_mask:0xf
    v_exp_f32 v48, v48
    v_fract_f32 v52, v52
k1_s32:
    s_cbranch_execz k1_ret
    v_exp_f32 v49, v49
    v_fract_f32 v53, v53
    v_exp_f32 v50, v50
    v_fract_f32 v54, v54
    v_exp_f32 v51, v51
    v_fract_f32 v55, v55
    v_cos_f32 v56, v52
    v_sin_f32 v60, v52
    v_cos_f32 v57, v53
    v_sin_f32 v61, v53
    v_cos_f32 v58, v54
    v_sin_f32 v62, v54
    v_cos_f32 v59, v55
    v_sin_f32 v63, v55
    v_mul_f32 v56, v48, v56
    v_mul_f32 v60, v48, v60
    v_mul_f32 v57, v49, v57
    v_mul_f32 v61, v49, v61
    v_mul_f32 v58, v50, v58
    v_mul_f32 v62, v50, v62
    v_mul_f32 v59, v51, v59
    v_mul_f32 v63, v51, v63
    v_cvt_pk_bf16_f32 v40, v56, v60
    v_cvt_pk_bf16_f32 v41, v57, v61
    v_cvt_pk_bf16_f32 v42, v58, v62
    v_cvt_pk_bf16_f32 v43, v59, v63
    v_mul_f32_dpp v48, v12, v64 row_newbcast:12 row_mask:0xf bank_mask:0xf
    v_mul_f32_dpp v52, v13, v64 row_newbcast:12 row_mask:0xf bank_mask:0xf
    v_mul_f32_dpp v49, v12, v64 row_newbcast:13 row_mask:0xf bank_mask:0xf
    v_mul_f32_dpp v53, v13, v64 row_newbcast:13 row_mask:0xf bank_mask:0xf
    v_mul_f32_dpp v50, v12, v64 row_newbcast:14 row_mask:0xf bank_mask:0xf
    v_mul_f32_dpp v54, v13, v64 row_newbcast:14 row_mask:0xf bank_mask:0xf
    v_mul_f32_dpp v51, v12, v64 row_newbcast:15 row_mask:0xf bank_mask:0xf
    v_mul_f32_dpp v55, v13, v64 row_newbcast:15 row_mask:0xf bank_mask:0xf
    v_exp_f32 v48, v48
    v_exp_f32 v49, v49
    v_exp_f32 v50, v50
    v_exp_f32 v51, v51
    v_cos_f32 v56, v52
    v_sin_f32 v60, v52
    v_cos_f32 v57, v53
    v_sin_f32 v61, v53
    v_cos_f32 v58, v54
    v_sin_f32 v62, v54
    v_cos_f32 v59, v55
    v_sin_f32 v63, v55
    v_mfma_f32_16x16x32_bf16 v[28:31], v[40:43], v[44:47], v[28:31]
    v_mul_f32 v56, v48, v56
    v_mul_f32 v60, v48, v60
    v_mul_f32 v57, v49, v57
k1_s33:
    s_cbranch_execz k1_ret
    v_mul_f32 v61, v49, v61
    v_mul_f32 v58, v50, v58
    v_mul_f32 v62, v50, v62
    v_mul_f32 v59, v51, v59
    v_mul_f32 v63, v51, v63
    s_barrier
    v_cvt_pk_bf16_f32 v32, v56, v60
    v_cvt_pk_bf16_f32 v33, v57, v61
    v_cvt_pk_bf16_f32 v34, v58, v62
    v_cvt_pk_bf16_f32 v35, v59, v63
    v_mul_f32_dpp v48, v16, v56 row_newbcast:12 row_mask:0xf bank_mask:0xf
    v_mul_f32_dpp v52, v17, v56 row_newbcast:12 row_mask:0xf bank_mask:0xf
    v_mul_f32_dpp v49, v16, v57 row_newbcast:13 row_mask:0xf bank_mask:0xf
    v_mul_f32_dpp v53, v17, v57 row_newbcast:13 row_mask:0xf bank_mask:0xf
    v_mul_f32_dpp v50, v16, v58 row_newbcast:14 row_mask:0xf bank_mask:0xf
    v_mul_f32_dpp v54, v17, v58 row_newbcast:14 row_mask:0xf bank_mask:0xf
    v_mul_f32_dpp v51, v16, v59 row_newbcast:15 row_mask:0xf bank_mask:0xf
    v_mul_f32_dpp v55, v17, v59 row_newbcast:15 row_mask:0xf bank_mask:0xf
    v_mfma_f32_16x16x32_bf16 v[20:23], v[32:35], v[44:47], v[20:23]
    v_fmac_f32_dpp v48, -v17, v60 row_newbcast:12 row_mask:0xf bank_mask:0xf
    v_fmac_f32_dpp v52, v16, v60 row_newbcast:12 row_mask:0xf bank_mask:0xf
    v_fmac_f32_dpp v49, -v17, v61 row_newbcast:13 row_mask:0xf bank_mask:0xf
    v_fmac_f32_dpp v53, v16, v61 row_newbcast:13 row_mask:0xf bank_mask:0xf
    v_fmac_f32_dpp v50, -v17, v62 row_newbcast:14 row_mask:0xf bank_mask:0xf
    v_fmac_f32_dpp v54, v16, v62 row_newbcast:14 row_mask:0xf bank_mask:0xf
    v_fmac_f32_dpp v51, -v17, v63 row_newbcast:15 row_mask:0xf bank_mask:0xf
    v_fmac_f32_dpp v55, v16, v63 row_newbcast:15 row_mask:0xf bank_mask:0xf
    v_cvt_pk_bf16_f32 v36, v48, v52
    v_cvt_pk_bf16_f32 v37, v49, v53
    v_cvt_pk_bf16_f32 v38, v50, v54
    v_cvt_pk_bf16_f32 v39, v51, v55
    s_nop 1
    v_mfma_f32_16x16x32_bf16 v[24:27], v[36:39], v[44:47], v[24:27]
    s_waitcnt vmcnt(0)
    v_cndmask_b32 v9, 0, v9, vcc
    s_barrier
    s_barrier
k1_s34:
    s_cbranch_execz k1_ret
    s_bitcmp1_b32 s15, 0
    s_cbranch_scc0 k1_kg_fin
    ds_write_b128 v67, v[28:31] offset:2048
    ds_write_b128 v67, v[20:23]
    v_mov_b32 v2, 1
    s_nop 2
    v_mov_b32 v25, v18
    ds_write_b128 v67, v[24:27] offset:1024
    ds_write_b32 v67, v2 offset:3072
    s_waitcnt lgkmcnt(0)
    s_endpgm
k1_kg_fin:
k1_kg_poll:
    ds_read_b32 v2, v67 offset:3072
    ds_read_b128 v[32:35], v67
    ds_read_b128 v[36:39], v67 offset:1024
    ds_read_b128 v[40:43], v67 offset:2048
    s_waitcnt lgkmcnt(0)
    v_readfirstlane_b32 s9, v2
    s_nop 0
    s_cmp_eq_u32 s9, 0
    s_cbranch_scc1 k1_kg_poll
    v_add_f32 v20, v20, v9
    v_mov_b32 v25, v18
    v_add_f32 v20, v20, v32
    v_add_f32 v21, v21, v33
    v_add_f32 v22, v22, v34
    v_add_f32 v23, v23, v35
    v_add_f32 v24, v24, v36
    v_add_f32 v25, v25, v37
    v_add_f32 v26, v26, v38
    v_add_f32 v28, v28, v40
    v_add_f32 v29, v29, v41
    v_add_f32 v30, v30, v42
    v_add_f32 v31, v31, v43
    v_cvt_pk_bf16_f32 v12, v20, v21
    v_cvt_pk_bf16_f32 v13, v22, v23
    buffer_store_dwordx2 v[12:13], v69, s[44:47], s11 offen sc0 sc1
    v_cvt_pk_bf16_f32 v14, v24, v26
    v_cvt_pk_bf16_f32 v15, v28, v29
    v_cvt_pk_bf16_f32 v16, v30, v31
    v_cvt_pk_bf16_f32 v17, v25, v25
    buffer_store_dword v14, v68, s[44:47], s11 offen offset:512 sc0 sc1
    buffer_store_dword v15, v70, s[44:47], s11 offen offset:768 sc0 sc1
    buffer_store_dword v16, v71, s[44:47], s11 offen offset:768 sc0 sc1
    buffer_store_dword v17, v72, s[44:47], s11 offen offset:1280 sc0 sc1
k1_end:
    s_endpgm
.globl k2_kernel
.p2align 8
.type k2_kernel,@function
k2_kernel:
k2_s0:
    s_cbranch_execz k2_end
    s_cmp_ge_u32 s2, 256
    s_cbranch_scc1 k2_end
    s_load_dwordx2 s[40:41], s[0:1], 112
    s_load_dwordx4 s[16:19], s[0:1], 88
    s_load_dwordx2 s[20:21], s[0:1], 0
    v_lshrrev_b32 v1, 6, v0
    v_and_b32 v0, 63, v0
    s_and_b32 s4, s2, 7
    v_readfirstlane_b32 s3, v1
    v_readfirstlane_b32 s94, v1
    s_lshr_b32 s5, s2, 3
    v_lshlrev_b32 v1, 4, v0
    s_lshl_b32 s6, s4, 2
    s_lshr_b32 s7, s5, 3
    s_add_u32 s6, s6, s7
    s_lshl_b32 s8, s6, 17
    s_add_u32 s8, s8, 2097152
    s_mul_i32 s9, s3, 2080
    s_lshl_b32 s10, s3, 11
    s_add_u32 s10, s10, s8
    s_mov_b32 m0, s9
    s_mov_b32 s46, 0x1000000
    s_mov_b32 s47, 0x00020000
    s_cmp_ge_u32 s3, 8
    s_cbranch_scc1 k2_conv
    s_and_b32 s7, s5, 7
    s_lshl_b32 s7, s7, 3
    s_add_u32 s7, s7, s3
    s_lshl_b32 s11, s6, 16
    s_lshl_b32 s12, s7, 10
    s_add_u32 s11, s11, s12
    s_add_u32 s11, s11, 0
    s_lshl_b32 s12, s7, 15
    s_lshl_b32 s13, s6, 10
    s_add_u32 s12, s12, s13
    s_add_u32 s12, s12, 6291456
    s_mov_b32 s24, 0
    v_mov_b32 v2, 0xdddddddd
    v_and_b32 v23, 15, v0
    v_lshrrev_b32 v24, 5, v0
    v_lshlrev_b32 v23, 4, v23
    v_lshl_add_u32 v30, v24, 8, v23
    v_add_u32 v30, 1024, v30
    v_add_u32 v31, 512, v30
    v_and_b32 v23, 16, v0
    v_cmp_eq_u32 vcc, 16, v23
    v_mov_b32 v24, 2064
    v_and_b32 v23, 27, v0
    v_mov_b32 v104, 163776
k2_s1:
    s_cbranch_execz k2_end
    v_cndmask_b32 v30, v30, v24, vcc
    v_cndmask_b32 v31, v31, v24, vcc
    v_cmp_eq_u32 vcc, 16, v23
    v_mov_b32 v24, 2048
    v_add_u32 v3, s9, v1
    s_nop 0
    v_cndmask_b32 v30, v30, v24, vcc
    v_cndmask_b32 v31, v31, v24, vcc
    v_mov_b32 v100, 0
    v_mov_b32 v101, 0
    v_mov_b32 v102, 0
    v_mov_b32 v103, 0
    v_mov_b32 v72, 0
    v_mov_b32 v73, 0
    v_mov_b32 v74, 0
    v_mov_b32 v75, 0
    v_mov_b32 v76, 0
    v_mov_b32 v77, 0
    v_mov_b32 v78, 0
    v_mov_b32 v79, 0
    v_mov_b32 v80, 0
    v_mov_b32 v81, 0
    v_mov_b32 v82, 0
    v_mov_b32 v83, 0
    v_mov_b32 v84, 0
    v_mov_b32 v85, 0
    v_mov_b32 v86, 0
    v_mov_b32 v87, 0
    v_mov_b32 v88, 0
    v_mov_b32 v89, 0
    v_mov_b32 v90, 0
    v_mov_b32 v91, 0
    v_mov_b32 v92, 0
    v_mov_b32 v93, 0
    v_mov_b32 v94, 0
    v_mov_b32 v95, 0
    s_cmp_lt_u32 s3, 4
    s_cbranch_scc1 k2_np
    s_setprio 1
k2_np:
    s_waitcnt lgkmcnt(0)
    s_mov_b32 s44, s40
    s_and_b32 s45, s41, 0xffff
    buffer_load_dwordx4 v1, s[44:47], s10 offen lds
    buffer_load_dwordx4 v[4:7], v1, s[44:47], s11 offen
    buffer_load_dwordx4 v1, s[44:47], s10 offen offset:1024 lds
    s_waitcnt vmcnt(1)
    ds_read_b128 v[8:11], v3
    s_waitcnt lgkmcnt(0)
    v_mfma_f32_32x32x16_bf16 v[48:63], v[8:11], v[4:7], 0
    s_nop 11
    v_max3_f32 v23, v48, v49, v50
    v_max3_f32 v23, v23, v51, v52
    v_max3_f32 v23, v23, v53, v54
k2_s2:
    s_cbranch_execz k2_end
    v_max3_f32 v23, v23, v55, v56
    v_max3_f32 v23, v23, v57, v58
    v_max3_f32 v23, v23, v59, v60
    v_max3_f32 v23, v23, v61, v62
    v_max_f32 v23, v23, v63
k2_start:
    v_mov_b32 v24, v23
    v_mov_b32 v3, v1
    v_mov_b32 v28, v30
    v_permlane32_swap_b32 v23, v24
    v_mov_b32 v29, v31
    s_mov_b32 s25, 0
    v_max_f32 v23, v23, v24
    v_sub_f32 v24, 0, v23
    v_pk_mov_b32 v[32:33], v[24:25], v[24:25] op_sel:[0,0]
    v_pk_mov_b32 v[34:35], v[24:25], v[24:25] op_sel:[0,0]
    v_pk_mov_b32 v[36:37], v[24:25], v[24:25] op_sel:[0,0]
    v_pk_mov_b32 v[38:39], v[24:25], v[24:25] op_sel:[0,0]
    v_pk_mov_b32 v[40:41], v[24:25], v[24:25] op_sel:[0,0]
    v_pk_mov_b32 v[42:43], v[24:25], v[24:25] op_sel:[0,0]
    v_pk_mov_b32 v[44:45], v[24:25], v[24:25] op_sel:[0,0]
    v_pk_mov_b32 v[46:47], v[24:25], v[24:25] op_sel:[0,0]
    s_cmp_lg_u32 s24, 0
    s_cbranch_scc1 k2_nobar
    s_waitcnt vmcnt(0)
    s_barrier
k2_nobar:
    ds_read_b128 v[8:11], v3
    ds_read_b128 v[12:15], v3 offset:2080
    ds_read_b128 v[16:19], v28
    ds_read_b128 v[20:23], v29
    s_waitcnt lgkmcnt(3)
    v_mfma_f32_32x32x16_bf16 v[48:63], v[8:11], v[4:7], v[32:47]
    s_nop 9
k2_loop:
    s_bitcmp1_b32 0x0a, s25
    s_cbranch_scc1 k2_poll
k2_body:
k2_t0:
    v_exp_f32 v48, v48
    v_exp_f32 v49, v49
    s_waitcnt lgkmcnt(0)
    v_smfmac_f32_32x32x32_bf16 v[80:95], v[100:103], v[72:79], v2
    ds_read_b128 v[8:11], v3 offset:4160
    v_exp_f32 v50, v50
    ds_read_b128 v[96:99], v28 offset:2080
    v_exp_f32 v51, v51
    ds_read_b128 v[100:103], v29 offset:2080
k2_s3:
    s_cbranch_execz k2_end
    v_exp_f32 v52, v52
    v_mfma_f32_32x32x16_bf16 v[64:79], v[12:15], v[4:7], v[32:47]
    v_exp_f32 v53, v53
    v_exp_f32 v54, v54
    v_exp_f32 v55, v55
    v_exp_f32 v56, v56
    v_exp_f32 v57, v57
    v_smfmac_f32_32x32x32_bf16 v[80:95], v[16:19], v[48:55], v2
    v_exp_f32 v58, v58
    v_exp_f32 v59, v59
    v_exp_f32 v60, v60
    v_exp_f32 v61, v61
    v_exp_f32 v62, v62
    v_exp_f32 v63, v63
k2_t1:
    v_exp_f32 v64, v64
    v_exp_f32 v65, v65
    s_waitcnt lgkmcnt(0)
    v_smfmac_f32_32x32x32_bf16 v[80:95], v[20:23], v[56:63], v2
    ds_read_b128 v[12:15], v3 offset:6240
    v_exp_f32 v66, v66
    ds_read_b128 v[16:19], v28 offset:4160
    v_exp_f32 v67, v67
    ds_read_b128 v[20:23], v29 offset:4160
    v_exp_f32 v68, v68
    v_mfma_f32_32x32x16_bf16 v[48:63], v[8:11], v[4:7], v[32:47]
    v_exp_f32 v69, v69
    v_exp_f32 v70, v70
    v_exp_f32 v71, v71
    v_exp_f32 v72, v72
    v_exp_f32 v73, v73
    v_smfmac_f32_32x32x32_bf16 v[80:95], v[96:99], v[64:71], v2
    v_exp_f32 v74, v74
    v_exp_f32 v75, v75
    v_exp_f32 v76, v76
    v_exp_f32 v77, v77
    v_exp_f32 v78, v78
    v_exp_f32 v79, v79
k2_t2:
    v_exp_f32 v48, v48
    v_exp_f32 v49, v49
    s_waitcnt lgkmcnt(0)
    v_smfmac_f32_32x32x32_bf16 v[80:95], v[100:103], v[72:79], v2
    ds_read_b128 v[8:11], v3 offset:8320
    v_exp_f32 v50, v50
    ds_read_b128 v[96:99], v28 offset:6240
    v_exp_f32 v51, v51
    ds_read_b128 v[100:103], v29 offset:6240
    v_exp_f32 v52, v52
    v_mfma_f32_32x32x16_bf16 v[64:79], v[12:15], v[4:7], v[32:47]
    v_exp_f32 v53, v53
    v_exp_f32 v54, v54
k2_s4:
    s_cbranch_execz k2_end
    v_exp_f32 v55, v55
    v_exp_f32 v56, v56
    v_exp_f32 v57, v57
    v_smfmac_f32_32x32x32_bf16 v[80:95], v[16:19], v[48:55], v2
    v_exp_f32 v58, v58
    v_exp_f32 v59, v59
    v_exp_f32 v60, v60
    v_exp_f32 v61, v61
    v_exp_f32 v62, v62
    v_exp_f32 v63, v63
k2_t3:
    v_exp_f32 v64, v64
    v_exp_f32 v65, v65
    s_waitcnt lgkmcnt(0)
    v_smfmac_f32_32x32x32_bf16 v[80:95], v[20:23], v[56:63], v2
    ds_read_b128 v[12:15], v3 offset:10400
    v_exp_f32 v66, v66
    ds_read_b128 v[16:19], v28 offset:8320
    v_exp_f32 v67, v67
    ds_read_b128 v[20:23], v29 offset:8320
    v_exp_f32 v68, v68
    v_mfma_f32_32x32x16_bf16 v[48:63], v[8:11], v[4:7], v[32:47]
    v_exp_f32 v69, v69
    v_exp_f32 v70, v70
    v_exp_f32 v71, v71
    v_exp_f32 v72, v72
    v_exp_f32 v73, v73
    v_smfmac_f32_32x32x32_bf16 v[80:95], v[96:99], v[64:71], v2
    v_exp_f32 v74, v74
    v_exp_f32 v75, v75
    v_exp_f32 v76, v76
    v_exp_f32 v77, v77
    v_exp_f32 v78, v78
    v_exp_f32 v79, v79
k2_t4:
    v_exp_f32 v48, v48
    v_exp_f32 v49, v49
    s_waitcnt lgkmcnt(0)
    v_smfmac_f32_32x32x32_bf16 v[80:95], v[100:103], v[72:79], v2
    ds_read_b128 v[8:11], v3 offset:12480
    v_exp_f32 v50, v50
    ds_read_b128 v[96:99], v28 offset:10400
    v_exp_f32 v51, v51
    ds_read_b128 v[100:103], v29 offset:10400
    v_exp_f32 v52, v52
    v_mfma_f32_32x32x16_bf16 v[64:79], v[12:15], v[4:7], v[32:47]
    v_exp_f32 v53, v53
    v_exp_f32 v54, v54
    v_exp_f32 v55, v55
    v_exp_f32 v56, v56
    v_exp_f32 v57, v57
    v_smfmac_f32_32x32x32_bf16 v[80:95], v[16:19], v[48:55], v2
k2_s5:
    s_cbranch_execz k2_end
    v_exp_f32 v58, v58
    v_exp_f32 v59, v59
    v_exp_f32 v60, v60
    v_exp_f32 v61, v61
    v_exp_f32 v62, v62
    v_exp_f32 v63, v63
k2_t5:
    v_exp_f32 v64, v64
    v_exp_f32 v65, v65
    s_waitcnt lgkmcnt(0)
    v_smfmac_f32_32x32x32_bf16 v[80:95], v[20:23], v[56:63], v2
    ds_read_b128 v[12:15], v3 offset:14560
    v_exp_f32 v66, v66
    ds_read_b128 v[16:19], v28 offset:12480
    v_exp_f32 v67, v67
    ds_read_b128 v[20:23], v29 offset:12480
    v_exp_f32 v68, v68
    v_mfma_f32_32x32x16_bf16 v[48:63], v[8:11], v[4:7], v[32:47]
    v_exp_f32 v69, v69
    v_exp_f32 v70, v70
    v_exp_f32 v71, v71
    v_exp_f32 v72, v72
    v_exp_f32 v73, v73
    v_smfmac_f32_32x32x32_bf16 v[80:95], v[96:99], v[64:71], v2
    v_exp_f32 v74, v74
    v_exp_f32 v75, v75
    v_exp_f32 v76, v76
    v_exp_f32 v77, v77
    v_exp_f32 v78, v78
    v_exp_f32 v79, v79
k2_t6:
    v_exp_f32 v48, v48
    v_exp_f32 v49, v49
    s_waitcnt lgkmcnt(0)
    v_smfmac_f32_32x32x32_bf16 v[80:95], v[100:103], v[72:79], v2
    ds_read_b128 v[8:11], v3 offset:16640
    v_exp_f32 v50, v50
    ds_read_b128 v[96:99], v28 offset:14560
    v_exp_f32 v51, v51
    ds_read_b128 v[100:103], v29 offset:14560
    v_exp_f32 v52, v52
    v_mfma_f32_32x32x16_bf16 v[64:79], v[12:15], v[4:7], v[32:47]
    v_exp_f32 v53, v53
    v_exp_f32 v54, v54
    v_exp_f32 v55, v55
    v_exp_f32 v56, v56
    v_exp_f32 v57, v57
    v_smfmac_f32_32x32x32_bf16 v[80:95], v[16:19], v[48:55], v2
    v_exp_f32 v58, v58
    v_exp_f32 v59, v59
    s_cmp_lg_u32 s25, 5
    s_cbranch_scc1 k2_ps
    s_setprio 0
k2_ps:
k2_s6:
    s_cbranch_execz k2_end
    v_exp_f32 v60, v60
    v_exp_f32 v61, v61
    v_exp_f32 v62, v62
    v_exp_f32 v63, v63
k2_t7:
    v_exp_f32 v64, v64
    v_exp_f32 v65, v65
    s_waitcnt lgkmcnt(0)
    v_smfmac_f32_32x32x32_bf16 v[80:95], v[20:23], v[56:63], v2
    ds_read_b128 v[12:15], v3 offset:18720
    v_exp_f32 v66, v66
    ds_read_b128 v[16:19], v28 offset:16640
    v_exp_f32 v67, v67
    ds_read_b128 v[20:23], v29 offset:16640
    v_exp_f32 v68, v68
    v_mfma_f32_32x32x16_bf16 v[48:63], v[8:11], v[4:7], v[32:47]
    v_exp_f32 v69, v69
    v_exp_f32 v70, v70
    v_exp_f32 v71, v71
    v_exp_f32 v72, v72
    v_exp_f32 v73, v73
    v_smfmac_f32_32x32x32_bf16 v[80:95], v[96:99], v[64:71], v2
    v_exp_f32 v74, v74
    v_exp_f32 v75, v75
    v_add_u32 v3, 16640, v3
    v_exp_f32 v76, v76
    v_add_u32 v28, 16640, v28
    v_exp_f32 v77, v77
    v_add_u32 v29, 16640, v29
    s_add_u32 s25, s25, 1
    v_exp_f32 v78, v78
    s_cmp_lt_u32 s25, 8
    v_exp_f32 v79, v79
    s_cbranch_scc1 k2_loop
    s_nop 0
    v_smfmac_f32_32x32x32_bf16 v[80:95], v[100:103], v[72:79], v2
    s_waitcnt lgkmcnt(0)
    s_nop 10
    v_mul_f32 v23, 0, v88
    v_fma_f32 v23, 0, v80, v23
    v_fma_f32 v23, 0, v81, v23
    v_fma_f32 v23, 0, v82, v23
    v_fma_f32 v23, 0, v83, v23
    v_fma_f32 v23, 0, v84, v23
    v_fma_f32 v23, 0, v85, v23
    v_fma_f32 v23, 0, v86, v23
    v_fma_f32 v23, 0, v87, v23
k2_s7:
    s_cbranch_execz k2_end
    v_add_f32 v23, v23, v88
    v_mov_b32 v24, 0x71800000
    v_cmp_nlt_f32 vcc, v23, v24
    v_rcp_f32 v25, v88
    s_cmp_lg_u32 s24, 0
    s_cbranch_scc1 k2_store
    s_cmp_lg_u64 vcc, 0
    s_cbranch_scc1 k2_fallback
k2_store:
    v_mul_f32 v80, v25, v80
    v_mul_f32 v81, v25, v81
    v_mul_f32 v82, v25, v82
    v_mul_f32 v83, v25, v83
    v_mul_f32 v84, v25, v84
    v_mul_f32 v85, v25, v85
    v_mul_f32 v86, v25, v86
    v_mul_f32 v87, v25, v87
    v_cvt_pk_bf16_f32 v24, v80, v81
    v_cvt_pk_bf16_f32 v25, v82, v83
    v_cvt_pk_bf16_f32 v26, v84, v85
    v_cvt_pk_bf16_f32 v27, v86, v87
    buffer_store_dwordx4 v[24:27], v1, s[44:47], s12 offen
    s_endpgm
k2_poll:
    ds_read_b64 v[106:107], v104
    s_waitcnt lgkmcnt(0)
    v_readfirstlane_b32 s26, v106
    v_readfirstlane_b32 s27, v107
    s_cmp_eq_u32 s25, 1
    s_cselect_b32 s26, s26, s27
    s_cmp_lt_u32 s26, 4
    s_cbranch_scc1 k2_poll
    s_branch k2_body
k2_fallback:
    s_mov_b32 s24, 1
    s_mov_b32 s25, 0
    v_mov_b32 v23, 0xff800000
    v_add_u32 v3, 131040, v1
    v_mov_b32 v100, 0
    v_mov_b32 v101, 0
    v_mov_b32 v102, 0
    v_mov_b32 v103, 0
    v_mov_b32 v72, 0
    v_mov_b32 v73, 0
    v_mov_b32 v74, 0
    v_mov_b32 v75, 0
    v_mov_b32 v76, 0
    v_mov_b32 v77, 0
    v_mov_b32 v78, 0
    v_mov_b32 v79, 0
    v_mov_b32 v80, 0
    v_mov_b32 v81, 0
    v_mov_b32 v82, 0
    v_mov_b32 v83, 0
    v_mov_b32 v84, 0
    v_mov_b32 v85, 0
    v_mov_b32 v86, 0
    v_mov_b32 v87, 0
    v_mov_b32 v88, 0
    v_mov_b32 v89, 0
    v_mov_b32 v90, 0
    v_mov_b32 v91, 0
    v_mov_b32 v92, 0
    v_mov_b32 v93, 0
    v_mov_b32 v94, 0
    v_mov_b32 v95, 0
k2_fb_loop:
    ds_read_b128 v[8:11], v3
    v_subrev_u32 v3, 2080, v3
    s_waitcnt lgkmcnt(0)
    v_mfma_f32_32x32x16_bf16 v[48:63], v[8:11], v[4:7], 0
    s_nop 11
    v_max3_f32 v23, v23, v48, v49
    v_max3_f32 v23, v23, v50, v51
    v_max3_f32 v23, v23, v52, v53
    v_max3_f32 v23, v23, v54, v55
    v_max3_f32 v23, v23, v56, v57
    v_max3_f32 v23, v23, v58, v59
    v_max3_f32 v23, v23, v60, v61
    v_max3_f32 v23, v23, v62, v63
    s_add_u32 s25, s25, 1
    s_cmp_lt_u32 s25, 64
    s_cbranch_scc1 k2_fb_loop
    s_branch k2_start
k2_conv:
k2_s8:
    s_cbranch_execz k2_end
    s_sub_u32 s3, s3, 8
    s_and_b32 s22, s3, 1
    s_lshr_b32 s23, s3, 1
    s_mul_i32 s12, s22, 12928
    s_add_u32 s12, s12, 133120
    v_mov_b32 v2, 163776
    v_mov_b32 v3, 1
    v_mov_b32 v8, 0
    v_mov_b32 v9, 0
    v_mov_b32 v10, 0
    v_mov_b32 v11, 0
    v_lshlrev_b32 v5, 3, v0
    v_add_u32 v6, s12, v1
    v_add_u32 v14, s12, v5
    s_cmp_ge_u32 s3, 2
    s_cbranch_scc1 k2_cv_i1
    ds_write_b64 v14, v[8:9] offset:12416
    s_mov_b64 exec, 3
    ds_write_b128 v6, v[8:11]
    ds_write_b128 v6, v[8:11] offset:4160
    v_add_u32 v4, v2, v1
    ds_write_b128 v4, v[8:11]
    s_mov_b64 exec, -1
    s_branch k2_cv_i2
k2_cv_i1:
    s_lshl_b32 s13, s22, 4
    v_mul_u32_u24 v4, 2080, v0
    s_cmp_eq_u32 s22, 0
    s_cselect_b32 s14, 0x3f803f80, 0
    v_add_u32 v4, s13, v4
    v_mov_b32 v8, s14
    v_mov_b32 v9, s14
    v_mov_b32 v10, s14
    v_mov_b32 v11, s14
    ds_write_b128 v4, v[8:11] offset:2048
k2_cv_i2:
    s_lshl_b32 s6, s4, 6
    s_lshl_b32 s7, s5, 1
    s_add_u32 s6, s6, s7
    s_add_u32 s11, s6, s22
    s_mul_i32 s11, s11, 1536
    s_add_u32 s11, s11, 8912896
    v_lshlrev_b32 v4, 2, v0
    v_lshlrev_b32 v7, 5, v0
    v_add_u32 v7, s12, v7
    v_lshlrev_b32 v12, 13, v0
    s_lshl_b32 s13, s3, 19
    s_lshl_b32 s14, s6, 1
    s_add_u32 s13, s13, s14
    s_add_u32 s27, s13, 4096
    s_mov_b32 s14, 0x01000100
k2_s9:
    s_cbranch_execz k2_end
    s_mov_b32 s15, 0x03020302
    s_mov_b32 s28, 0x05040302
    s_mov_b32 s29, 0x05040100
    s_mov_b32 s30, 0x07060302
    s_waitcnt lgkmcnt(0)
    s_mov_b32 s44, s40
    s_and_b32 s45, s41, 0xffff
    buffer_load_dwordx4 v1, s[44:47], s10 offen lds
    buffer_load_dwordx4 v1, s[44:47], s10 offen offset:1024 lds
    s_mov_b32 s52, s18
    s_and_b32 s53, s19, 0xffff
    s_mov_b32 s54, 0x400000
    s_mov_b32 s55, 0x00020000
    s_mov_b32 s48, s16
    s_and_b32 s49, s17, 0xffff
    s_mov_b32 s50, 0x80000
    s_mov_b32 s51, 0x00020000
    s_mov_b32 s56, s20
    s_and_b32 s57, s21, 0xffff
    s_mov_b32 s58, 0x200000
    s_mov_b32 s59, 0x00020000
    s_add_u32 s31, s10, 65536
    s_add_u32 s33, s10, 106496
    .p2align 7
    s_waitcnt vmcnt(0)
    s_barrier
    s_setprio 2
k2_dl0:
    s_add_u32 m0, m0, 8320
    s_add_u32 s10, s10, 8192
    buffer_load_dwordx4 v1, s[44:47], s10 offen lds
    s_cmp_lt_u32 s10, s31
    buffer_load_dwordx4 v1, s[44:47], s10 offen offset:1024 lds
    s_cbranch_scc1 k2_dl0
    s_waitcnt vmcnt(8)
    s_mov_b64 exec, 1
    ds_add_u32 v2, v3 offset:0
    s_mov_b64 exec, -1
k2_dl1:
    s_add_u32 m0, m0, 8320
    s_add_u32 s10, s10, 8192
k2_s10:
    s_cbranch_execz k2_end
    buffer_load_dwordx4 v1, s[44:47], s10 offen lds
    s_cmp_lt_u32 s10, s33
    buffer_load_dwordx4 v1, s[44:47], s10 offen offset:1024 lds
    s_cbranch_scc1 k2_dl1
    s_cmp_lg_u32 s23, 0
    s_cbranch_scc1 k2_cv_l1
    buffer_load_dwordx3 v[72:74], v5, s[44:47], s11 offen
    buffer_load_dwordx2 v[76:77], v4, s[44:47], s11 offen offset:512
    buffer_load_dwordx2 v[78:79], v4, s[44:47], s11 offen offset:768
    s_waitcnt vmcnt(3)
    s_branch k2_cv_l2
k2_cv_l1:
    buffer_load_dwordx2 v[80:81], v4, s[44:47], s11 offen offset:1024
    s_waitcnt vmcnt(1)
k2_cv_l2:
    s_mov_b64 exec, 1
    ds_add_u32 v2, v3 offset:4
    s_mov_b64 exec, -1
    buffer_load_dword v64, v12, s[56:59], s13 offen offset:0
    buffer_load_dword v65, v12, s[56:59], s13 offen offset:1024
    buffer_load_dword v66, v12, s[56:59], s13 offen offset:2048
    buffer_load_dword v67, v12, s[56:59], s13 offen offset:3072
    buffer_load_dword v68, v12, s[56:59], s27 offen offset:0
    buffer_load_dword v69, v12, s[56:59], s27 offen offset:1024
    buffer_load_dword v70, v12, s[56:59], s27 offen offset:2048
    buffer_load_dword v71, v12, s[56:59], s27 offen offset:3072
    s_waitcnt vmcnt(8)
    s_cbranch_scc1 k2_cv_e1
    ds_write_b64 v14, v[72:73] offset:32
    v_perm_b32 v8, v73, v72, s28
    v_perm_b32 v9, v74, v73, s28
    ds_write_b64 v14, v[8:9] offset:4192
    v_perm_b32 v24, v76, v76, s14
    v_perm_b32 v25, v77, v76, s28
    v_mov_b32 v26, v76
    v_perm_b32 v27, v77, v77, s14
    ds_write_b64 v14, v[24:25] offset:544
    ds_write_b64 v14, v[26:27] offset:4704
    v_perm_b32 v16, v78, v78, s14
    v_mov_b32 v17, v78
k2_s11:
    s_cbranch_execz k2_end
    v_perm_b32 v18, v78, v78, s15
    v_perm_b32 v19, v79, v79, s14
    v_perm_b32 v20, v78, v78, s14
    v_perm_b32 v21, v78, v78, s15
    v_perm_b32 v22, v79, v78, s28
    v_perm_b32 v23, v79, v79, s14
    ds_write_b128 v6, v[16:19] offset:1056
    ds_write_b128 v6, v[20:23] offset:5216
    v_lshlrev_b32 v28, 16, v72
    s_mov_b64 exec, 1
    ds_write_b32 v6, v28 offset:4188
    s_mov_b64 exec, -1
    s_branch k2_cv_e2
k2_cv_e1:
    v_perm_b32 v24, v80, v80, s14
    v_perm_b32 v25, v80, v80, s14
    v_mov_b32 v26, v80
    v_perm_b32 v27, v80, v80, s15
    v_perm_b32 v28, v80, v80, s15
    v_perm_b32 v29, v80, v80, s15
    v_perm_b32 v30, v81, v81, s14
    v_perm_b32 v31, v81, v81, s14
    v_perm_b32 v32, v80, v80, s14
    v_perm_b32 v33, v80, v80, s14
    v_perm_b32 v34, v80, v80, s15
    v_perm_b32 v35, v80, v80, s15
    v_perm_b32 v36, v80, v80, s15
    v_perm_b32 v37, v81, v80, s28
    v_perm_b32 v38, v81, v81, s14
    v_perm_b32 v39, v81, v81, s14
    ds_write_b128 v7, v[24:27] offset:2080
    ds_write_b128 v7, v[28:31] offset:2096
    ds_write_b128 v7, v[32:35] offset:6240
    ds_write_b128 v7, v[36:39] offset:6256
k2_cv_e2:
    s_lshl_b32 s13, s3, 10
    s_sub_u32 s13, 145520, s13
    v_sub_u32 v8, s13, v1
    v_and_b32 v13, 15, v0
    v_lshrrev_b32 v14, 4, v0
    v_add_u32 v15, 1, v13
    v_lshrrev_b32 v16, 1, v15
    v_lshl_add_u32 v16, v14, 2, v16
    v_lshlrev_b32 v16, 2, v16
    v_and_b32 v15, 1, v15
    v_mul_u32_u24 v15, 4160, v15
    s_lshl_b32 s13, s23, 8
    s_add_u32 s13, s13, s12
    v_add3_u32 v4, v15, v16, s13
    v_add_u32 v5, 1024, v4
    v_add_u32 v6, 2048, v4
    v_add_u32 v7, 3072, v4
    v_lshlrev_b32 v15, 5, v13
    v_lshlrev_b32 v16, 4, v14
    v_sub_u32 v12, v16, v15
    s_add_u32 s13, s13, 8800
    v_add_u32 v12, s13, v12
    v_lshlrev_b32 v13, 15, v13
    v_lshl_add_u32 v13, v14, 13, v13
    s_lshl_b32 s11, s5, 2
    s_add_u32 s11, s11, s3
    s_lshl_b32 s11, s11, 12
    v_lshlrev_b32 v9, 6, v0
    s_waitcnt vmcnt(0)
    buffer_load_dword v10, v9, s[48:51], s11 offen
    v_perm_b32 v16, v70, v71, s29
    v_perm_b32 v17, v68, v69, s29
    v_perm_b32 v18, v66, v67, s29
    v_perm_b32 v19, v64, v65, s29
    v_perm_b32 v20, v70, v71, s30
    v_perm_b32 v21, v68, v69, s30
    v_perm_b32 v22, v66, v67, s30
    v_perm_b32 v23, v64, v65, s30
    ds_write_b128 v8, v[16:19]
    ds_write_b128 v8, v[20:23] offset:12928
    s_waitcnt lgkmcnt(0)
    s_mov_b64 exec, 1
    ds_add_u32 v2, v3 offset:8
    s_mov_b64 exec, -1
    s_setprio 0
    s_branch k2_pc_in
k2_pc:
    s_nop 15
    s_nop 15
    s_nop 15
    s_nop 15
k2_pc_in:
    ds_read_b32 v15, v2 offset:8
    s_waitcnt lgkmcnt(0)
    v_readfirstlane_b32 s26, v15
    s_cmp_lt_u32 s26, 4
    s_cbranch_scc1 k2_pc
    s_setprio 0
    ds_read2_b32 v[32:33], v4 offset0:0 offset1:1
    ds_read2_b32 v[34:35], v4 offset0:2 offset1:3
    ds_read_b128 v[64:67], v12 offset:3584
    ds_read2_b32 v[36:37], v4 offset0:128 offset1:129
    ds_read2_b32 v[38:39], v4 offset0:130 offset1:131
    ds_read_b128 v[68:71], v12 offset:3072
    ds_read2_b32 v[40:41], v5 offset0:0 offset1:1
    ds_read2_b32 v[42:43], v5 offset0:2 offset1:3
    ds_read_b128 v[72:75], v12 offset:2560
    ds_read2_b32 v[44:45], v5 offset0:128 offset1:129
    ds_read2_b32 v[46:47], v5 offset0:130 offset1:131
    ds_read_b128 v[76:79], v12 offset:2048
    ds_read2_b32 v[48:49], v6 offset0:0 offset1:1
    ds_read2_b32 v[50:51], v6 offset0:2 offset1:3
    ds_read_b128 v[80:83], v12 offset:1536
    ds_read2_b32 v[52:53], v6 offset0:128 offset1:129
    ds_read2_b32 v[54:55], v6 offset0:130 offset1:131
    ds_read_b128 v[84:87], v12 offset:1024
    ds_read2_b32 v[56:57], v7 offset0:0 offset1:1
    ds_read2_b32 v[58:59], v7 offset0:2 offset1:3
    ds_read_b128 v[88:91], v12 offset:512
    ds_read2_b32 v[60:61], v7 offset0:128 offset1:129
    ds_read2_b32 v[62:63], v7 offset0:130 offset1:131
    ds_read_b128 v[92:95], v12 offset:0
    s_waitcnt lgkmcnt(15)
    v_mfma_f32_16x16x32_bf16 v[96:99], v[32:35], v[64:67], 0
    s_waitcnt lgkmcnt(15)
    v_mfma_f32_16x16x32_bf16 v[100:103], v[36:39], v[64:67], 0
    v_mfma_f32_16x16x32_bf16 v[104:107], v[36:39], v[68:71], 0
    v_mfma_f32_16x16x32_bf16 v[100:103], v[32:35], v[68:71], v[100:103]
    s_waitcnt lgkmcnt(15)
    v_mfma_f32_16x16x32_bf16 v[104:107], v[40:43], v[64:67], v[104:107]
    v_mfma_f32_16x16x32_bf16 v[108:111], v[40:43], v[68:71], 0
    v_mfma_f32_16x16x32_bf16 v[112:115], v[40:43], v[72:75], 0
    v_mfma_f32_16x16x32_bf16 v[104:107], v[32:35], v[72:75], v[104:107]
    v_mfma_f32_16x16x32_bf16 v[108:111], v[36:39], v[72:75], v[108:111]
    s_waitcnt lgkmcnt(12)
    v_mfma_f32_16x16x32_bf16 v[108:111], v[44:47], v[64:67], v[108:111]
    v_mfma_f32_16x16x32_bf16 v[112:115], v[44:47], v[68:71], v[112:115]
    v_mfma_f32_16x16x32_bf16 v[116:119], v[44:47], v[72:75], 0
    v_mfma_f32_16x16x32_bf16 v[120:123], v[44:47], v[76:79], 0
    v_mfma_f32_16x16x32_bf16 v[108:111], v[32:35], v[76:79], v[108:111]
    v_mfma_f32_16x16x32_bf16 v[112:115], v[36:39], v[76:79], v[112:115]
    v_mfma_f32_16x16x32_bf16 v[116:119], v[40:43], v[76:79], v[116:119]
    s_waitcnt lgkmcnt(9)
    v_mfma_f32_16x16x32_bf16 v[112:115], v[48:51], v[64:67], v[112:115]
    v_mfma_f32_16x16x32_bf16 v[116:119], v[48:51], v[68:71], v[116:119]
    v_mfma_f32_16x16x32_bf16 v[120:123], v[48:51], v[72:75], v[120:123]
    v_mfma_f32_16x16x32_bf16 v[124:127], v[48:51], v[76:79], 0
    v_mfma_f32_16x16x32_bf16 v[112:115], v[32:35], v[80:83], v[112:115]
    v_mfma_f32_16x16x32_bf16 v[116:119], v[36:39], v[80:83], v[116:119]
    v_mfma_f32_16x16x32_bf16 v[120:123], v[40:43], v[80:83], v[120:123]
    v_mfma_f32_16x16x32_bf16 v[124:127], v[44:47], v[80:83], v[124:127]
    s_waitcnt lgkmcnt(6)
    v_mfma_f32_16x16x32_bf16 v[116:119], v[52:55], v[64:67], v[116:119]
    v_mfma_f32_16x16x32_bf16 v[120:123], v[52:55], v[68:71], v[120:123]
    v_mfma_f32_16x16x32_bf16 v[124:127], v[52:55], v[72:75], v[124:127]
    v_mfma_f32_16x16x32_bf16 v[116:119], v[32:35], v[84:87], v[116:119]
    v_mfma_f32_16x16x32_bf16 v[120:123], v[36:39], v[84:87], v[120:123]
    v_mfma_f32_16x16x32_bf16 v[124:127], v[40:43], v[84:87], v[124:127]
    s_waitcnt lgkmcnt(3)
    v_mfma_f32_16x16x32_bf16 v[120:123], v[56:59], v[64:67], v[120:123]
    v_mfma_f32_16x16x32_bf16 v[124:127], v[56:59], v[68:71], v[124:127]
    v_mfma_f32_16x16x32_bf16 v[120:123], v[32:35], v[88:91], v[120:123]
    v_mfma_f32_16x16x32_bf16 v[124:127], v[36:39], v[88:91], v[124:127]
    s_waitcnt lgkmcnt(0)
    v_mfma_f32_16x16x32_bf16 v[124:127], v[60:63], v[64:67], v[124:127]
    v_mfma_f32_16x16x32_bf16 v[124:127], v[32:35], v[92:95], v[124:127]
    ds_read2_b32 v[32:33], v4 offset0:16 offset1:17
    ds_read2_b32 v[34:35], v4 offset0:18 offset1:19
    ds_read_b128 v[64:67], v12 offset:3648
    ds_read2_b32 v[36:37], v4 offset0:144 offset1:145
    ds_read2_b32 v[38:39], v4 offset0:146 offset1:147
    ds_read_b128 v[68:71], v12 offset:3136
    ds_read2_b32 v[40:41], v5 offset0:16 offset1:17
    ds_read2_b32 v[42:43], v5 offset0:18 offset1:19
    ds_read_b128 v[72:75], v12 offset:2624
    ds_read2_b32 v[44:45], v5 offset0:144 offset1:145
    ds_read2_b32 v[46:47], v5 offset0:146 offset1:147
    ds_read_b128 v[76:79], v12 offset:2112
    ds_read2_b32 v[48:49], v6 offset0:16 offset1:17
    ds_read2_b32 v[50:51], v6 offset0:18 offset1:19
    ds_read_b128 v[80:83], v12 offset:1600
    ds_read2_b32 v[52:53], v6 offset0:144 offset1:145
    ds_read2_b32 v[54:55], v6 offset0:146 offset1:147
    ds_read_b128 v[84:87], v12 offset:1088
    ds_read2_b32 v[56:57], v7 offset0:16 offset1:17
    ds_read2_b32 v[58:59], v7 offset0:18 offset1:19
    ds_read_b128 v[88:91], v12 offset:576
    ds_read2_b32 v[60:61], v7 offset0:144 offset1:145
    ds_read2_b32 v[62:63], v7 offset0:146 offset1:147
    ds_read_b128 v[92:95], v12 offset:64
    s_waitcnt lgkmcnt(15)
    v_mfma_f32_16x16x32_bf16 v[96:99], v[32:35], v[64:67], v[96:99]
    s_waitcnt lgkmcnt(15)
    v_mfma_f32_16x16x32_bf16 v[100:103], v[36:39], v[64:67], v[100:103]
    v_mfma_f32_16x16x32_bf16 v[104:107], v[36:39], v[68:71], v[104:107]
    v_mfma_f32_16x16x32_bf16 v[100:103], v[32:35], v[68:71], v[100:103]
    s_waitcnt lgkmcnt(15)
    v_mfma_f32_16x16x32_bf16 v[104:107], v[40:43], v[64:67], v[104:107]
    v_mfma_f32_16x16x32_bf16 v[108:111], v[40:43], v[68:71], v[108:111]
    v_mfma_f32_16x16x32_bf16 v[112:115], v[40:43], v[72:75], v[112:115]
    v_mfma_f32_16x16x32_bf16 v[104:107], v[32:35], v[72:75], v[104:107]
    v_mfma_f32_16x16x32_bf16 v[108:111], v[36:39], v[72:75], v[108:111]
    s_waitcnt lgkmcnt(12)
    v_mfma_f32_16x16x32_bf16 v[108:111], v[44:47], v[64:67], v[108:111]
    v_mfma_f32_16x16x32_bf16 v[112:115], v[44:47], v[68:71], v[112:115]
    v_mfma_f32_16x16x32_bf16 v[116:119], v[44:47], v[72:75], v[116:119]
    v_mfma_f32_16x16x32_bf16 v[120:123], v[44:47], v[76:79], v[120:123]
    v_mfma_f32_16x16x32_bf16 v[108:111], v[32:35], v[76:79], v[108:111]
    v_mfma_f32_16x16x32_bf16 v[112:115], v[36:39], v[76:79], v[112:115]
    v_mfma_f32_16x16x32_bf16 v[116:119], v[40:43], v[76:79], v[116:119]
    s_waitcnt lgkmcnt(9)
    v_mfma_f32_16x16x32_bf16 v[112:115], v[48:51], v[64:67], v[112:115]
    v_mfma_f32_16x16x32_bf16 v[116:119], v[48:51], v[68:71], v[116:119]
    v_mfma_f32_16x16x32_bf16 v[120:123], v[48:51], v[72:75], v[120:123]
    v_mfma_f32_16x16x32_bf16 v[124:127], v[48:51], v[76:79], v[124:127]
    v_mfma_f32_16x16x32_bf16 v[112:115], v[32:35], v[80:83], v[112:115]
    v_mfma_f32_16x16x32_bf16 v[116:119], v[36:39], v[80:83], v[116:119]
    v_mfma_f32_16x16x32_bf16 v[120:123], v[40:43], v[80:83], v[120:123]
    v_mfma_f32_16x16x32_bf16 v[124:127], v[44:47], v[80:83], v[124:127]
    s_waitcnt lgkmcnt(6)
    v_mfma_f32_16x16x32_bf16 v[116:119], v[52:55], v[64:67], v[116:119]
    v_mfma_f32_16x16x32_bf16 v[120:123], v[52:55], v[68:71], v[120:123]
    v_mfma_f32_16x16x32_bf16 v[124:127], v[52:55], v[72:75], v[124:127]
    v_mfma_f32_16x16x32_bf16 v[116:119], v[32:35], v[84:87], v[116:119]
    v_mfma_f32_16x16x32_bf16 v[120:123], v[36:39], v[84:87], v[120:123]
    v_mfma_f32_16x16x32_bf16 v[124:127], v[40:43], v[84:87], v[124:127]
    s_waitcnt lgkmcnt(3)
    v_mfma_f32_16x16x32_bf16 v[120:123], v[56:59], v[64:67], v[120:123]
    v_mfma_f32_16x16x32_bf16 v[124:127], v[56:59], v[68:71], v[124:127]
    v_mfma_f32_16x16x32_bf16 v[120:123], v[32:35], v[88:91], v[120:123]
    v_mfma_f32_16x16x32_bf16 v[124:127], v[36:39], v[88:91], v[124:127]
    s_waitcnt lgkmcnt(0)
    v_mfma_f32_16x16x32_bf16 v[124:127], v[60:63], v[64:67], v[124:127]
    v_mfma_f32_16x16x32_bf16 v[124:127], v[32:35], v[92:95], v[124:127]
    ds_read2_b32 v[32:33], v4 offset0:32 offset1:33
    ds_read2_b32 v[34:35], v4 offset0:34 offset1:35
    ds_read_b128 v[64:67], v12 offset:3712
    ds_read2_b32 v[36:37], v4 offset0:160 offset1:161
    ds_read2_b32 v[38:39], v4 offset0:162 offset1:163
    ds_read_b128 v[68:71], v12 offset:3200
    ds_read2_b32 v[40:41], v5 offset0:32 offset1:33
    ds_read2_b32 v[42:43], v5 offset0:34 offset1:35
    ds_read_b128 v[72:75], v12 offset:2688
    ds_read2_b32 v[44:45], v5 offset0:160 offset1:161
    ds_read2_b32 v[46:47], v5 offset0:162 offset1:163
    ds_read_b128 v[76:79], v12 offset:2176
    ds_read2_b32 v[48:49], v6 offset0:32 offset1:33
    ds_read2_b32 v[50:51], v6 offset0:34 offset1:35
    ds_read_b128 v[80:83], v12 offset:1664
    ds_read2_b32 v[52:53], v6 offset0:160 offset1:161
    ds_read2_b32 v[54:55], v6 offset0:162 offset1:163
    ds_read_b128 v[84:87], v12 offset:1152
    ds_read2_b32 v[56:57], v7 offset0:32 offset1:33
    ds_read2_b32 v[58:59], v7 offset0:34 offset1:35
    ds_read_b128 v[88:91], v12 offset:640
    ds_read2_b32 v[60:61], v7 offset0:160 offset1:161
    ds_read2_b32 v[62:63], v7 offset0:162 offset1:163
    ds_read_b128 v[92:95], v12 offset:128
    s_waitcnt lgkmcnt(15)
    v_mfma_f32_16x16x32_bf16 v[96:99], v[32:35], v[64:67], v[96:99]
    s_waitcnt lgkmcnt(15)
    v_mfma_f32_16x16x32_bf16 v[100:103], v[36:39], v[64:67], v[100:103]
    v_mfma_f32_16x16x32_bf16 v[104:107], v[36:39], v[68:71], v[104:107]
    v_mfma_f32_16x16x32_bf16 v[100:103], v[32:35], v[68:71], v[100:103]
    s_waitcnt lgkmcnt(15)
    v_mfma_f32_16x16x32_bf16 v[104:107], v[40:43], v[64:67], v[104:107]
    v_mfma_f32_16x16x32_bf16 v[108:111], v[40:43], v[68:71], v[108:111]
    v_mfma_f32_16x16x32_bf16 v[112:115], v[40:43], v[72:75], v[112:115]
    v_mfma_f32_16x16x32_bf16 v[104:107], v[32:35], v[72:75], v[104:107]
    v_mfma_f32_16x16x32_bf16 v[108:111], v[36:39], v[72:75], v[108:111]
    s_waitcnt lgkmcnt(12)
    v_mfma_f32_16x16x32_bf16 v[108:111], v[44:47], v[64:67], v[108:111]
    v_mfma_f32_16x16x32_bf16 v[112:115], v[44:47], v[68:71], v[112:115]
    v_mfma_f32_16x16x32_bf16 v[116:119], v[44:47], v[72:75], v[116:119]
    v_mfma_f32_16x16x32_bf16 v[120:123], v[44:47], v[76:79], v[120:123]
    v_mfma_f32_16x16x32_bf16 v[108:111], v[32:35], v[76:79], v[108:111]
    v_mfma_f32_16x16x32_bf16 v[112:115], v[36:39], v[76:79], v[112:115]
    v_mfma_f32_16x16x32_bf16 v[116:119], v[40:43], v[76:79], v[116:119]
    s_waitcnt lgkmcnt(9)
    v_mfma_f32_16x16x32_bf16 v[112:115], v[48:51], v[64:67], v[112:115]
    v_mfma_f32_16x16x32_bf16 v[116:119], v[48:51], v[68:71], v[116:119]
    v_mfma_f32_16x16x32_bf16 v[120:123], v[48:51], v[72:75], v[120:123]
    v_mfma_f32_16x16x32_bf16 v[124:127], v[48:51], v[76:79], v[124:127]
    v_mfma_f32_16x16x32_bf16 v[112:115], v[32:35], v[80:83], v[112:115]
    v_mfma_f32_16x16x32_bf16 v[116:119], v[36:39], v[80:83], v[116:119]
    v_mfma_f32_16x16x32_bf16 v[120:123], v[40:43], v[80:83], v[120:123]
    v_mfma_f32_16x16x32_bf16 v[124:127], v[44:47], v[80:83], v[124:127]
    s_waitcnt lgkmcnt(6)
    v_mfma_f32_16x16x32_bf16 v[116:119], v[52:55], v[64:67], v[116:119]
    v_mfma_f32_16x16x32_bf16 v[120:123], v[52:55], v[68:71], v[120:123]
    v_mfma_f32_16x16x32_bf16 v[124:127], v[52:55], v[72:75], v[124:127]
    v_mfma_f32_16x16x32_bf16 v[116:119], v[32:35], v[84:87], v[116:119]
    v_mfma_f32_16x16x32_bf16 v[120:123], v[36:39], v[84:87], v[120:123]
    v_mfma_f32_16x16x32_bf16 v[124:127], v[40:43], v[84:87], v[124:127]
    s_waitcnt lgkmcnt(3)
    v_mfma_f32_16x16x32_bf16 v[120:123], v[56:59], v[64:67], v[120:123]
    v_mfma_f32_16x16x32_bf16 v[124:127], v[56:59], v[68:71], v[124:127]
    v_mfma_f32_16x16x32_bf16 v[120:123], v[32:35], v[88:91], v[120:123]
    v_mfma_f32_16x16x32_bf16 v[124:127], v[36:39], v[88:91], v[124:127]
    s_waitcnt lgkmcnt(0)
    v_mfma_f32_16x16x32_bf16 v[124:127], v[60:63], v[64:67], v[124:127]
    v_mfma_f32_16x16x32_bf16 v[124:127], v[32:35], v[92:95], v[124:127]
    ds_read2_b32 v[32:33], v4 offset0:48 offset1:49
    ds_read2_b32 v[34:35], v4 offset0:50 offset1:51
    ds_read_b128 v[64:67], v12 offset:3776
    ds_read2_b32 v[36:37], v4 offset0:176 offset1:177
    ds_read2_b32 v[38:39], v4 offset0:178 offset1:179
    ds_read_b128 v[68:71], v12 offset:3264
    ds_read2_b32 v[40:41], v5 offset0:48 offset1:49
    ds_read2_b32 v[42:43], v5 offset0:50 offset1:51
    ds_read_b128 v[72:75], v12 offset:2752
    ds_read2_b32 v[44:45], v5 offset0:176 offset1:177
    ds_read2_b32 v[46:47], v5 offset0:178 offset1:179
    ds_read_b128 v[76:79], v12 offset:2240
    ds_read2_b32 v[48:49], v6 offset0:48 offset1:49
    ds_read2_b32 v[50:51], v6 offset0:50 offset1:51
    ds_read_b128 v[80:83], v12 offset:1728
    ds_read2_b32 v[52:53], v6 offset0:176 offset1:177
    ds_read2_b32 v[54:55], v6 offset0:178 offset1:179
    ds_read_b128 v[84:87], v12 offset:1216
    ds_read2_b32 v[56:57], v7 offset0:48 offset1:49
    ds_read2_b32 v[58:59], v7 offset0:50 offset1:51
    ds_read_b128 v[88:91], v12 offset:704
    ds_read2_b32 v[60:61], v7 offset0:176 offset1:177
    ds_read2_b32 v[62:63], v7 offset0:178 offset1:179
    ds_read_b128 v[92:95], v12 offset:192
    s_waitcnt lgkmcnt(15)
    v_mfma_f32_16x16x32_bf16 v[96:99], v[32:35], v[64:67], v[96:99]
    s_waitcnt lgkmcnt(15)
    v_mfma_f32_16x16x32_bf16 v[100:103], v[36:39], v[64:67], v[100:103]
    v_mfma_f32_16x16x32_bf16 v[104:107], v[36:39], v[68:71], v[104:107]
    v_mfma_f32_16x16x32_bf16 v[100:103], v[32:35], v[68:71], v[100:103]
    s_waitcnt lgkmcnt(15)
    v_mfma_f32_16x16x32_bf16 v[104:107], v[40:43], v[64:67], v[104:107]
    v_mfma_f32_16x16x32_bf16 v[108:111], v[40:43], v[68:71], v[108:111]
    v_mfma_f32_16x16x32_bf16 v[112:115], v[40:43], v[72:75], v[112:115]
    v_mfma_f32_16x16x32_bf16 v[104:107], v[32:35], v[72:75], v[104:107]
    v_mfma_f32_16x16x32_bf16 v[108:111], v[36:39], v[72:75], v[108:111]
    s_waitcnt lgkmcnt(12)
    v_mfma_f32_16x16x32_bf16 v[108:111], v[44:47], v[64:67], v[108:111]
    v_mfma_f32_16x16x32_bf16 v[112:115], v[44:47], v[68:71], v[112:115]
    v_mfma_f32_16x16x32_bf16 v[116:119], v[44:47], v[72:75], v[116:119]
    v_mfma_f32_16x16x32_bf16 v[120:123], v[44:47], v[76:79], v[120:123]
    v_mfma_f32_16x16x32_bf16 v[108:111], v[32:35], v[76:79], v[108:111]
    v_mfma_f32_16x16x32_bf16 v[112:115], v[36:39], v[76:79], v[112:115]
    v_mfma_f32_16x16x32_bf16 v[116:119], v[40:43], v[76:79], v[116:119]
    s_waitcnt lgkmcnt(9)
    v_mfma_f32_16x16x32_bf16 v[112:115], v[48:51], v[64:67], v[112:115]
    v_mfma_f32_16x16x32_bf16 v[116:119], v[48:51], v[68:71], v[116:119]
    v_mfma_f32_16x16x32_bf16 v[120:123], v[48:51], v[72:75], v[120:123]
    v_mfma_f32_16x16x32_bf16 v[124:127], v[48:51], v[76:79], v[124:127]
    v_mfma_f32_16x16x32_bf16 v[112:115], v[32:35], v[80:83], v[112:115]
    v_mfma_f32_16x16x32_bf16 v[116:119], v[36:39], v[80:83], v[116:119]
    v_mfma_f32_16x16x32_bf16 v[120:123], v[40:43], v[80:83], v[120:123]
    v_mfma_f32_16x16x32_bf16 v[124:127], v[44:47], v[80:83], v[124:127]
    s_waitcnt lgkmcnt(6)
    v_mfma_f32_16x16x32_bf16 v[116:119], v[52:55], v[64:67], v[116:119]
    v_mfma_f32_16x16x32_bf16 v[120:123], v[52:55], v[68:71], v[120:123]
    v_mfma_f32_16x16x32_bf16 v[124:127], v[52:55], v[72:75], v[124:127]
    v_mfma_f32_16x16x32_bf16 v[116:119], v[32:35], v[84:87], v[116:119]
    v_mfma_f32_16x16x32_bf16 v[120:123], v[36:39], v[84:87], v[120:123]
    v_mfma_f32_16x16x32_bf16 v[124:127], v[40:43], v[84:87], v[124:127]
    s_waitcnt lgkmcnt(3)
    v_mfma_f32_16x16x32_bf16 v[120:123], v[56:59], v[64:67], v[120:123]
    v_mfma_f32_16x16x32_bf16 v[124:127], v[56:59], v[68:71], v[124:127]
    v_mfma_f32_16x16x32_bf16 v[120:123], v[32:35], v[88:91], v[120:123]
    v_mfma_f32_16x16x32_bf16 v[124:127], v[36:39], v[88:91], v[124:127]
    s_waitcnt lgkmcnt(0)
    v_mfma_f32_16x16x32_bf16 v[124:127], v[60:63], v[64:67], v[124:127]
    v_mfma_f32_16x16x32_bf16 v[124:127], v[32:35], v[92:95], v[124:127]
    s_mov_b64 exec, 1
    ds_add_u32 v2, v3 offset:12
    s_mov_b64 exec, -1
    v_add_u32 v4, 133120, v1
    s_lshl_b32 s8, s3, 20
    s_lshl_b32 s9, s6, 1
    s_add_u32 s8, s8, s9
    s_add_u32 s9, s8, 524288
    s_add_u32 s10, s8, 4096
    s_add_u32 s11, s9, 4096
    s_setprio 0
    s_branch k2_pd_in
k2_pd:
    s_nop 15
    s_nop 15
    s_nop 15
    s_nop 15
k2_pd_in:
    ds_read_b32 v15, v2 offset:12
    s_waitcnt lgkmcnt(0)
    v_readfirstlane_b32 s26, v15
    s_cmp_lt_u32 s26, 4
    s_cbranch_scc1 k2_pd
    s_setprio 2
    s_cmp_eq_u32 s3, 1
    s_cbranch_scc1 k2_cx1
    s_cmp_eq_u32 s3, 2
    s_cbranch_scc1 k2_cx2
    s_cmp_eq_u32 s3, 3
    s_cbranch_scc1 k2_cx3
k2_cx0:
    ds_write_b128 v4, v[104:107] offset:6144
    ds_write_b128 v4, v[108:111] offset:7168
    ds_write_b128 v4, v[112:115] offset:12288
    ds_write_b128 v4, v[116:119] offset:13312
    ds_write_b128 v4, v[120:123] offset:18432
    ds_write_b128 v4, v[124:127] offset:19456
    s_waitcnt lgkmcnt(0)
    s_mov_b64 exec, 1
    ds_add_u32 v2, v3 offset:16
    s_mov_b64 exec, -1
    s_setprio 0
    s_branch k2_pe0_in
k2_pe0:
    s_nop 15
    s_nop 15
    s_nop 15
    s_nop 15
k2_pe0_in:
    ds_read_b32 v15, v2 offset:16
    s_waitcnt lgkmcnt(0)
    v_readfirstlane_b32 s26, v15
    s_cmp_lt_u32 s26, 4
    s_cbranch_scc1 k2_pe0
    s_setprio 2
    ds_read_b128 v[32:35], v4 offset:0
    ds_read_b128 v[36:39], v4 offset:1024
    ds_read_b128 v[40:43], v4 offset:2048
    ds_read_b128 v[44:47], v4 offset:3072
    ds_read_b128 v[48:51], v4 offset:4096
    ds_read_b128 v[52:55], v4 offset:5120
    s_waitcnt lgkmcnt(0)
    v_pk_add_f32 v[64:65], v[96:97], v[40:41]
    v_pk_add_f32 v[66:67], v[98:99], v[42:43]
    v_pk_add_f32 v[68:69], v[100:101], v[44:45]
    v_pk_add_f32 v[70:71], v[102:103], v[46:47]
    v_pk_add_f32 v[72:73], v[32:33], v[48:49]
    v_pk_add_f32 v[74:75], v[34:35], v[50:51]
    v_pk_add_f32 v[76:77], v[36:37], v[52:53]
    v_pk_add_f32 v[78:79], v[38:39], v[54:55]
    s_branch k2_cv_out
k2_cx1:
    ds_write_b128 v4, v[96:99] offset:0
    ds_write_b128 v4, v[100:103] offset:1024
    ds_write_b128 v4, v[112:115] offset:14336
    ds_write_b128 v4, v[116:119] offset:15360
    ds_write_b128 v4, v[120:123] offset:20480
    ds_write_b128 v4, v[124:127] offset:21504
    s_waitcnt lgkmcnt(0)
    s_mov_b64 exec, 1
    ds_add_u32 v2, v3 offset:16
    s_mov_b64 exec, -1
    s_setprio 0
    s_branch k2_pe1_in
k2_pe1:
    s_nop 15
    s_nop 15
    s_nop 15
    s_nop 15
k2_pe1_in:
    ds_read_b32 v15, v2 offset:16
    s_waitcnt lgkmcnt(0)
    v_readfirstlane_b32 s26, v15
    s_cmp_lt_u32 s26, 4
    s_cbranch_scc1 k2_pe1
    s_setprio 2
    ds_read_b128 v[32:35], v4 offset:6144
    ds_read_b128 v[36:39], v4 offset:7168
    ds_read_b128 v[40:43], v4 offset:8192
    ds_read_b128 v[44:47], v4 offset:9216
    ds_read_b128 v[48:51], v4 offset:10240
    ds_read_b128 v[52:55], v4 offset:11264
    s_waitcnt lgkmcnt(0)
    v_pk_add_f32 v[64:65], v[32:33], v[40:41]
    v_pk_add_f32 v[66:67], v[34:35], v[42:43]
    v_pk_add_f32 v[68:69], v[36:37], v[44:45]
    v_pk_add_f32 v[70:71], v[38:39], v[46:47]
    v_pk_add_f32 v[72:73], v[104:105], v[48:49]
    v_pk_add_f32 v[74:75], v[106:107], v[50:51]
    v_pk_add_f32 v[76:77], v[108:109], v[52:53]
    v_pk_add_f32 v[78:79], v[110:111], v[54:55]
    s_branch k2_cv_out
k2_cx2:
    ds_write_b128 v4, v[96:99] offset:2048
    ds_write_b128 v4, v[100:103] offset:3072
    ds_write_b128 v4, v[104:107] offset:8192
    ds_write_b128 v4, v[108:111] offset:9216
    ds_write_b128 v4, v[120:123] offset:22528
    ds_write_b128 v4, v[124:127] offset:23552
    s_waitcnt lgkmcnt(0)
    s_mov_b64 exec, 1
    ds_add_u32 v2, v3 offset:16
    s_mov_b64 exec, -1
    s_setprio 0
    s_branch k2_pe2_in
k2_pe2:
    s_nop 15
    s_nop 15
    s_nop 15
    s_nop 15
k2_pe2_in:
    ds_read_b32 v15, v2 offset:16
    s_waitcnt lgkmcnt(0)
    v_readfirstlane_b32 s26, v15
    s_cmp_lt_u32 s26, 4
    s_cbranch_scc1 k2_pe2
    s_setprio 2
    ds_read_b128 v[32:35], v4 offset:12288
    ds_read_b128 v[36:39], v4 offset:13312
    ds_read_b128 v[40:43], v4 offset:14336
    ds_read_b128 v[44:47], v4 offset:15360
    ds_read_b128 v[48:51], v4 offset:16384
    ds_read_b128 v[52:55], v4 offset:17408
    s_waitcnt lgkmcnt(0)
    v_pk_add_f32 v[64:65], v[32:33], v[112:113]
    v_pk_add_f32 v[66:67], v[34:35], v[114:115]
    v_pk_add_f32 v[68:69], v[36:37], v[116:117]
    v_pk_add_f32 v[70:71], v[38:39], v[118:119]
    v_pk_add_f32 v[72:73], v[40:41], v[48:49]
    v_pk_add_f32 v[74:75], v[42:43], v[50:51]
    v_pk_add_f32 v[76:77], v[44:45], v[52:53]
    v_pk_add_f32 v[78:79], v[46:47], v[54:55]
    s_branch k2_cv_out
k2_cx3:
    ds_write_b128 v4, v[96:99] offset:4096
    ds_write_b128 v4, v[100:103] offset:5120
    ds_write_b128 v4, v[104:107] offset:10240
    ds_write_b128 v4, v[108:111] offset:11264
    ds_write_b128 v4, v[112:115] offset:16384
    ds_write_b128 v4, v[116:119] offset:17408
    s_waitcnt lgkmcnt(0)
    s_mov_b64 exec, 1
    ds_add_u32 v2, v3 offset:16
    s_mov_b64 exec, -1
    s_setprio 0
    s_branch k2_pe3_in
k2_pe3:
    s_nop 15
    s_nop 15
    s_nop 15
    s_nop 15
k2_pe3_in:
    ds_read_b32 v15, v2 offset:16
    s_waitcnt lgkmcnt(0)
    v_readfirstlane_b32 s26, v15
    s_cmp_lt_u32 s26, 4
    s_cbranch_scc1 k2_pe3
    s_setprio 2
    ds_read_b128 v[32:35], v4 offset:18432
    ds_read_b128 v[36:39], v4 offset:19456
    ds_read_b128 v[40:43], v4 offset:20480
    ds_read_b128 v[44:47], v4 offset:21504
    ds_read_b128 v[48:51], v4 offset:22528
    ds_read_b128 v[52:55], v4 offset:23552
    s_waitcnt lgkmcnt(0)
    v_pk_add_f32 v[64:65], v[32:33], v[48:49]
    v_pk_add_f32 v[66:67], v[34:35], v[50:51]
    v_pk_add_f32 v[68:69], v[36:37], v[52:53]
    v_pk_add_f32 v[70:71], v[38:39], v[54:55]
    v_pk_add_f32 v[72:73], v[40:41], v[120:121]
    v_pk_add_f32 v[74:75], v[42:43], v[122:123]
    v_pk_add_f32 v[76:77], v[44:45], v[124:125]
    v_pk_add_f32 v[78:79], v[46:47], v[126:127]
k2_cv_out:
    v_cvt_pk_bf16_f32 v16, v64, v72
    v_cvt_pk_bf16_f32 v17, v65, v73
    v_cvt_pk_bf16_f32 v18, v66, v74
    v_cvt_pk_bf16_f32 v19, v67, v75
    v_cvt_pk_bf16_f32 v20, v68, v76
    v_cvt_pk_bf16_f32 v21, v69, v77
    v_cvt_pk_bf16_f32 v22, v70, v78
    v_cvt_pk_bf16_f32 v23, v71, v79
    buffer_store_dword v16, v13, s[52:55], s8 offen offset:0
    buffer_store_dword v17, v13, s[52:55], s8 offen offset:2048
    buffer_store_dword v18, v13, s[52:55], s10 offen offset:0
    buffer_store_dword v19, v13, s[52:55], s10 offen offset:2048
    buffer_store_dword v20, v13, s[52:55], s9 offen offset:0
    buffer_store_dword v21, v13, s[52:55], s9 offen offset:2048
    buffer_store_dword v22, v13, s[52:55], s11 offen offset:0
    buffer_store_dword v23, v13, s[52:55], s11 offen offset:2048
    s_bfe_u32 s92, s2, 196611
    s_and_b32 s93, s94, 3
    s_lshl2_add_u32 s92, s92, s93
    s_mov_b64 exec, 0
    s_cmp_eq_u32 s92, 0
    s_cbranch_scc1 k3_s0
    s_cmp_eq_u32 s92, 1
    s_cbranch_scc1 k3_s1
    s_cmp_eq_u32 s92, 2
    s_cbranch_scc1 k3_s2
    s_cmp_eq_u32 s92, 3
    s_cbranch_scc1 k3_s3
    s_cmp_eq_u32 s92, 4
    s_cbranch_scc1 k3_s4
    s_cmp_eq_u32 s92, 5
    s_cbranch_scc1 k3_s5
    s_cmp_eq_u32 s92, 6
    s_cbranch_scc1 k3_s6
    s_cmp_eq_u32 s92, 7
    s_cbranch_scc1 k3_s7
    s_cmp_eq_u32 s92, 8
    s_cbranch_scc1 k3_s8
    s_cmp_eq_u32 s92, 9
    s_cbranch_scc1 k3_s9
    s_endpgm
k2_end:
    s_endpgm
.globl k3_kernel
.p2align 8
.type k3_kernel,@function
k3_kernel:
k3_s0:
    s_cbranch_execz k3_end
    s_cmp_ge_u32 s2, 256
    s_cbranch_scc1 k3_end
    s_load_dwordx2 s[40:41], s[0:1], 112
    s_load_dwordx4 s[16:19], s[0:1], 88
    v_lshrrev_b32 v1, 6, v0
    v_and_b32 v0, 63, v0
    s_and_b32 s4, s2, 7
    v_readfirstlane_b32 s3, v1
    v_readfirstlane_b32 s94, v1
    s_lshr_b32 s5, s2, 3
    v_lshlrev_b32 v1, 4, v0
    s_lshl_b32 s6, s4, 2
    s_lshr_b32 s7, s5, 3
    s_add_u32 s6, s6, s7
    s_and_b32 s7, s5, 7
    s_and_b32 s10, s3, 1
    s_bfe_u32 s11, s3, 0x10001
    s_cmp_ge_u32 s3, 4
    s_cbranch_scc1 k3_mm
    s_lshl_b32 s12, s3, 11
    s_lshl_b32 s8, s6, 16
    s_lshl_b32 s9, s11, 15
    s_add_u32 s8, s8, s9
    s_lshl_b32 s9, s10, 11
    s_add_u32 s8, s8, s9
    s_add_u32 s8, s8, 6291456
    v_lshrrev_b32 v2, 3, v0
    v_and_b32 v3, 7, v0
    v_bfe_u32 v4, v0, 4, 1
    v_lshlrev_b32 v4, 2, v4
    v_xor_b32 v3, v3, v4
    v_lshlrev_b32 v2, 10, v2
    v_lshl_add_u32 v2, v3, 4, v2
    v_add_u32 v3, 7168, v2
    s_lshl_b32 s9, s7, 7
    s_lshl_b32 s13, s3, 14
    s_add_u32 s9, s9, s13
    s_and_b32 s60, s7, 0
    s_mov_b32 s46, 0x1000000
    s_mov_b32 s47, 0x00020000
    s_mov_b32 s50, 0x80000
    s_mov_b32 s51, 0x00020000
    s_waitcnt lgkmcnt(0)
    s_mov_b32 s44, s40
    s_and_b32 s45, s41, 0xffff
    s_mov_b32 s48, s16
    s_and_b32 s49, s17, 0xffff
    s_add_u32 m0, s12, 0
    s_lshl_b32 s14, s60, 12
k3_s1:
    s_cbranch_execz k3_end
    s_add_u32 s14, s14, s8
    buffer_load_dwordx4 v1, s[44:47], s14 offen lds
    buffer_load_dwordx4 v1, s[44:47], s14 offen offset:1024 lds
    s_add_u32 m0, s12, 8192
    s_lshl_b32 s14, s60, 16
    s_add_u32 s14, s14, s9
    buffer_load_dwordx4 v2, s[48:51], s14 offen lds
    buffer_load_dwordx4 v3, s[48:51], s14 offen offset:1024 lds
    s_add_u32 s60, s60, 1
    s_and_b32 s60, s60, 7
    s_add_u32 m0, s12, 16384
    s_lshl_b32 s14, s60, 12
    s_add_u32 s14, s14, s8
    buffer_load_dwordx4 v1, s[44:47], s14 offen lds
    buffer_load_dwordx4 v1, s[44:47], s14 offen offset:1024 lds
    s_add_u32 m0, s12, 24576
    s_lshl_b32 s14, s60, 16
    s_add_u32 s14, s14, s9
    buffer_load_dwordx4 v2, s[48:51], s14 offen lds
    buffer_load_dwordx4 v3, s[48:51], s14 offen offset:1024 lds
    s_add_u32 s60, s60, 1
    s_and_b32 s60, s60, 7
    s_add_u32 m0, s12, 32768
    s_lshl_b32 s14, s60, 12
    s_add_u32 s14, s14, s8
    buffer_load_dwordx4 v1, s[44:47], s14 offen lds
    buffer_load_dwordx4 v1, s[44:47], s14 offen offset:1024 lds
    s_add_u32 m0, s12, 40960
    s_lshl_b32 s14, s60, 16
    s_add_u32 s14, s14, s9
    buffer_load_dwordx4 v2, s[48:51], s14 offen lds
    buffer_load_dwordx4 v3, s[48:51], s14 offen offset:1024 lds
    s_add_u32 s60, s60, 1
    s_and_b32 s60, s60, 7
    s_add_u32 m0, s12, 49152
    s_lshl_b32 s14, s60, 12
    s_add_u32 s14, s14, s8
    buffer_load_dwordx4 v1, s[44:47], s14 offen lds
    buffer_load_dwordx4 v1, s[44:47], s14 offen offset:1024 lds
    s_add_u32 m0, s12, 57344
    s_lshl_b32 s14, s60, 16
    s_add_u32 s14, s14, s9
k3_s2:
    s_cbranch_execz k3_end
    buffer_load_dwordx4 v2, s[48:51], s14 offen lds
    buffer_load_dwordx4 v3, s[48:51], s14 offen offset:1024 lds
    s_add_u32 s60, s60, 1
    s_and_b32 s60, s60, 7
    s_waitcnt vmcnt(12)
    s_barrier
    s_add_u32 m0, s12, 65536
    s_lshl_b32 s14, s60, 12
    s_add_u32 s14, s14, s8
    buffer_load_dwordx4 v1, s[44:47], s14 offen lds
    buffer_load_dwordx4 v1, s[44:47], s14 offen offset:1024 lds
    s_add_u32 m0, s12, 73728
    s_lshl_b32 s14, s60, 16
    s_add_u32 s14, s14, s9
    buffer_load_dwordx4 v2, s[48:51], s14 offen lds
    buffer_load_dwordx4 v3, s[48:51], s14 offen offset:1024 lds
    s_add_u32 s60, s60, 1
    s_and_b32 s60, s60, 7
    s_waitcnt vmcnt(12)
    s_barrier
    s_add_u32 m0, s12, 81920
    s_lshl_b32 s14, s60, 12
    s_add_u32 s14, s14, s8
    buffer_load_dwordx4 v1, s[44:47], s14 offen lds
    buffer_load_dwordx4 v1, s[44:47], s14 offen offset:1024 lds
    s_add_u32 m0, s12, 90112
    s_lshl_b32 s14, s60, 16
    s_add_u32 s14, s14, s9
    buffer_load_dwordx4 v2, s[48:51], s14 offen lds
    buffer_load_dwordx4 v3, s[48:51], s14 offen offset:1024 lds
    s_add_u32 s60, s60, 1
    s_and_b32 s60, s60, 7
    s_waitcnt vmcnt(12)
    s_barrier
    s_add_u32 m0, s12, 98304
    s_lshl_b32 s14, s60, 12
    s_add_u32 s14, s14, s8
    buffer_load_dwordx4 v1, s[44:47], s14 offen lds
    buffer_load_dwordx4 v1, s[44:47], s14 offen offset:1024 lds
    s_add_u32 m0, s12, 106496
    s_lshl_b32 s14, s60, 16
    s_add_u32 s14, s14, s9
    buffer_load_dwordx4 v2, s[48:51], s14 offen lds
    buffer_load_dwordx4 v3, s[48:51], s14 offen offset:1024 lds
k3_s3:
    s_cbranch_execz k3_end
    s_add_u32 s60, s60, 1
    s_and_b32 s60, s60, 7
    s_waitcnt vmcnt(12)
    s_barrier
    s_add_u32 m0, s12, 114688
    s_lshl_b32 s14, s60, 12
    s_add_u32 s14, s14, s8
    buffer_load_dwordx4 v1, s[44:47], s14 offen lds
    buffer_load_dwordx4 v1, s[44:47], s14 offen offset:1024 lds
    s_add_u32 m0, s12, 122880
    s_lshl_b32 s14, s60, 16
    s_add_u32 s14, s14, s9
    buffer_load_dwordx4 v2, s[48:51], s14 offen lds
    buffer_load_dwordx4 v3, s[48:51], s14 offen offset:1024 lds
    s_add_u32 s60, s60, 1
    s_and_b32 s60, s60, 7
    s_waitcnt vmcnt(12)
    s_barrier
    s_waitcnt vmcnt(8)
    s_barrier
    s_waitcnt vmcnt(4)
    s_barrier
    s_waitcnt vmcnt(0)
    s_barrier
    s_endpgm
k3_mm:
    s_lshl_b32 s12, s10, 12
    v_add_u32 v2, s12, v1
    v_lshrrev_b32 v5, 5, v0
    v_bfe_u32 v3, v0, 2, 2
    v_lshl_add_u32 v3, v5, 2, v3
    v_lshlrev_b32 v3, 7, v3
    v_bfe_u32 v4, v0, 3, 1
    v_xor_b32 v4, s11, v4
    v_lshl_add_u32 v3, v4, 6, v3
    v_and_b32 v4, 1, v0
    v_lshl_add_u32 v3, v4, 5, v3
    v_bfe_u32 v4, v0, 4, 1
    v_lshl_add_u32 v3, v4, 4, v3
    v_bfe_u32 v4, v0, 1, 1
    v_lshl_add_u32 v3, v4, 3, v3
    v_add_u32 v3, 8192, v3
    v_add_u32 v6, 65536, v2
    v_add_u32 v7, 65536, v3
    s_lshl_b32 s12, s6, 1
    s_add_u32 s12, s12, s10
k3_s4:
    s_cbranch_execz k3_end
    s_lshl_b32 s12, s12, 16
    s_lshl_b32 s13, s7, 1
    s_add_u32 s13, s13, s11
    s_lshl_b32 s13, s13, 6
    s_add_u32 s12, s12, s13
    s_add_u32 s12, s12, 1024
    s_add_u32 s13, s12, 32768
    s_lshl_b32 s14, s3, 12
    v_and_b32 v4, 31, v0
    v_mul_u32_u24 v4, 80, v4
    v_lshl_add_u32 v4, v5, 5, v4
    v_add_u32 v4, s14, v4
    v_lshrrev_b32 v5, 2, v0
    v_and_b32 v9, 3, v0
    v_lshlrev_b32 v9, 4, v9
    v_lshl_add_u32 v8, v5, 11, v9
    v_mul_u32_u24 v5, 80, v5
    v_add3_u32 v5, v5, v9, s14
    s_waitcnt lgkmcnt(0)
    s_mov_b32 s52, s18
    s_and_b32 s53, s19, 0xffff
    s_mov_b32 s54, 0x400000
    s_mov_b32 s55, 0x00020000
    s_barrier
    ds_read_b128 v[16:19], v2 offset:0
    ds_read_b64_tr_b16 v[20:21], v3 offset:0
    ds_read_b64_tr_b16 v[22:23], v3 offset:1024
    ds_read_b128 v[24:27], v2 offset:1024
    ds_read_b64_tr_b16 v[28:29], v3 offset:2048
    ds_read_b64_tr_b16 v[30:31], v3 offset:3072
    ds_read_b128 v[32:35], v2 offset:2048
    ds_read_b64_tr_b16 v[36:37], v3 offset:4096
    ds_read_b64_tr_b16 v[38:39], v3 offset:5120
    ds_read_b128 v[40:43], v2 offset:3072
    ds_read_b64_tr_b16 v[44:45], v3 offset:6144
    ds_read_b64_tr_b16 v[46:47], v3 offset:7168
    s_waitcnt lgkmcnt(9)
    v_mfma_f32_32x32x16_bf16 v[80:95], v[20:23], v[16:19], 0
    s_waitcnt lgkmcnt(6)
    v_mfma_f32_32x32x16_bf16 v[80:95], v[28:31], v[24:27], v[80:95]
k3_s5:
    s_cbranch_execz k3_end
    s_waitcnt lgkmcnt(3)
    v_mfma_f32_32x32x16_bf16 v[80:95], v[36:39], v[32:35], v[80:95]
    s_waitcnt lgkmcnt(0)
    v_mfma_f32_32x32x16_bf16 v[80:95], v[44:47], v[40:43], v[80:95]
    s_barrier
    ds_read_b128 v[48:51], v2 offset:16384
    ds_read_b64_tr_b16 v[52:53], v3 offset:16384
    ds_read_b64_tr_b16 v[54:55], v3 offset:17408
    ds_read_b128 v[56:59], v2 offset:17408
    ds_read_b64_tr_b16 v[60:61], v3 offset:18432
    ds_read_b64_tr_b16 v[62:63], v3 offset:19456
    ds_read_b128 v[64:67], v2 offset:18432
    ds_read_b64_tr_b16 v[68:69], v3 offset:20480
    ds_read_b64_tr_b16 v[70:71], v3 offset:21504
    ds_read_b128 v[72:75], v2 offset:19456
    ds_read_b64_tr_b16 v[76:77], v3 offset:22528
    ds_read_b64_tr_b16 v[78:79], v3 offset:23552
    s_waitcnt lgkmcnt(9)
    v_mfma_f32_32x32x16_bf16 v[80:95], v[52:55], v[48:51], v[80:95]
    s_waitcnt lgkmcnt(6)
    v_mfma_f32_32x32x16_bf16 v[80:95], v[60:63], v[56:59], v[80:95]
    s_waitcnt lgkmcnt(3)
    v_mfma_f32_32x32x16_bf16 v[80:95], v[68:71], v[64:67], v[80:95]
    s_waitcnt lgkmcnt(0)
    v_mfma_f32_32x32x16_bf16 v[80:95], v[76:79], v[72:75], v[80:95]
    s_barrier
    ds_read_b128 v[16:19], v2 offset:32768
    ds_read_b64_tr_b16 v[20:21], v3 offset:32768
    ds_read_b64_tr_b16 v[22:23], v3 offset:33792
    ds_read_b128 v[24:27], v2 offset:33792
    ds_read_b64_tr_b16 v[28:29], v3 offset:34816
    ds_read_b64_tr_b16 v[30:31], v3 offset:35840
    ds_read_b128 v[32:35], v2 offset:34816
    ds_read_b64_tr_b16 v[36:37], v3 offset:36864
    ds_read_b64_tr_b16 v[38:39], v3 offset:37888
    ds_read_b128 v[40:43], v2 offset:35840
k3_s6:
    s_cbranch_execz k3_end
    ds_read_b64_tr_b16 v[44:45], v3 offset:38912
    ds_read_b64_tr_b16 v[46:47], v3 offset:39936
    s_waitcnt lgkmcnt(9)
    v_mfma_f32_32x32x16_bf16 v[80:95], v[20:23], v[16:19], v[80:95]
    s_waitcnt lgkmcnt(6)
    v_mfma_f32_32x32x16_bf16 v[80:95], v[28:31], v[24:27], v[80:95]
    s_waitcnt lgkmcnt(3)
    v_mfma_f32_32x32x16_bf16 v[80:95], v[36:39], v[32:35], v[80:95]
    s_waitcnt lgkmcnt(0)
    v_mfma_f32_32x32x16_bf16 v[80:95], v[44:47], v[40:43], v[80:95]
    s_barrier
    ds_read_b128 v[48:51], v2 offset:49152
    ds_read_b64_tr_b16 v[52:53], v3 offset:49152
    ds_read_b64_tr_b16 v[54:55], v3 offset:50176
    ds_read_b128 v[56:59], v2 offset:50176
    ds_read_b64_tr_b16 v[60:61], v3 offset:51200
    ds_read_b64_tr_b16 v[62:63], v3 offset:52224
    ds_read_b128 v[64:67], v2 offset:51200
    ds_read_b64_tr_b16 v[68:69], v3 offset:53248
    ds_read_b64_tr_b16 v[70:71], v3 offset:54272
    ds_read_b128 v[72:75], v2 offset:52224
    ds_read_b64_tr_b16 v[76:77], v3 offset:55296
    ds_read_b64_tr_b16 v[78:79], v3 offset:56320
    s_waitcnt lgkmcnt(9)
    v_mfma_f32_32x32x16_bf16 v[80:95], v[52:55], v[48:51], v[80:95]
    s_waitcnt lgkmcnt(6)
    v_mfma_f32_32x32x16_bf16 v[80:95], v[60:63], v[56:59], v[80:95]
    s_waitcnt lgkmcnt(3)
    v_mfma_f32_32x32x16_bf16 v[80:95], v[68:71], v[64:67], v[80:95]
    s_waitcnt lgkmcnt(0)
    v_mfma_f32_32x32x16_bf16 v[80:95], v[76:79], v[72:75], v[80:95]
    s_barrier
    ds_read_b128 v[16:19], v6 offset:0
    ds_read_b64_tr_b16 v[20:21], v7 offset:0
    ds_read_b64_tr_b16 v[22:23], v7 offset:1024
    ds_read_b128 v[24:27], v6 offset:1024
    ds_read_b64_tr_b16 v[28:29], v7 offset:2048
k3_s7:
    s_cbranch_execz k3_end
    ds_read_b64_tr_b16 v[30:31], v7 offset:3072
    ds_read_b128 v[32:35], v6 offset:2048
    ds_read_b64_tr_b16 v[36:37], v7 offset:4096
    ds_read_b64_tr_b16 v[38:39], v7 offset:5120
    ds_read_b128 v[40:43], v6 offset:3072
    ds_read_b64_tr_b16 v[44:45], v7 offset:6144
    ds_read_b64_tr_b16 v[46:47], v7 offset:7168
    s_waitcnt lgkmcnt(9)
    v_mfma_f32_32x32x16_bf16 v[80:95], v[20:23], v[16:19], v[80:95]
    s_waitcnt lgkmcnt(6)
    v_mfma_f32_32x32x16_bf16 v[80:95], v[28:31], v[24:27], v[80:95]
    s_waitcnt lgkmcnt(3)
    v_mfma_f32_32x32x16_bf16 v[80:95], v[36:39], v[32:35], v[80:95]
    s_waitcnt lgkmcnt(0)
    v_mfma_f32_32x32x16_bf16 v[80:95], v[44:47], v[40:43], v[80:95]
    s_barrier
    ds_read_b128 v[48:51], v6 offset:16384
    ds_read_b64_tr_b16 v[52:53], v7 offset:16384
    ds_read_b64_tr_b16 v[54:55], v7 offset:17408
    ds_read_b128 v[56:59], v6 offset:17408
    ds_read_b64_tr_b16 v[60:61], v7 offset:18432
    ds_read_b64_tr_b16 v[62:63], v7 offset:19456
    ds_read_b128 v[64:67], v6 offset:18432
    ds_read_b64_tr_b16 v[68:69], v7 offset:20480
    ds_read_b64_tr_b16 v[70:71], v7 offset:21504
    ds_read_b128 v[72:75], v6 offset:19456
    ds_read_b64_tr_b16 v[76:77], v7 offset:22528
    ds_read_b64_tr_b16 v[78:79], v7 offset:23552
    s_waitcnt lgkmcnt(9)
    v_mfma_f32_32x32x16_bf16 v[80:95], v[52:55], v[48:51], v[80:95]
    s_waitcnt lgkmcnt(6)
    v_mfma_f32_32x32x16_bf16 v[80:95], v[60:63], v[56:59], v[80:95]
    s_waitcnt lgkmcnt(3)
    v_mfma_f32_32x32x16_bf16 v[80:95], v[68:71], v[64:67], v[80:95]
    s_waitcnt lgkmcnt(0)
    v_mfma_f32_32x32x16_bf16 v[80:95], v[76:79], v[72:75], v[80:95]
k3_s8:
    s_cbranch_execz k3_end
    s_barrier
    ds_read_b128 v[16:19], v6 offset:32768
    ds_read_b64_tr_b16 v[20:21], v7 offset:32768
    ds_read_b64_tr_b16 v[22:23], v7 offset:33792
    ds_read_b128 v[24:27], v6 offset:33792
    ds_read_b64_tr_b16 v[28:29], v7 offset:34816
    ds_read_b64_tr_b16 v[30:31], v7 offset:35840
    ds_read_b128 v[32:35], v6 offset:34816
    ds_read_b64_tr_b16 v[36:37], v7 offset:36864
    ds_read_b64_tr_b16 v[38:39], v7 offset:37888
    ds_read_b128 v[40:43], v6 offset:35840
    ds_read_b64_tr_b16 v[44:45], v7 offset:38912
    ds_read_b64_tr_b16 v[46:47], v7 offset:39936
    s_waitcnt lgkmcnt(9)
    v_mfma_f32_32x32x16_bf16 v[80:95], v[20:23], v[16:19], v[80:95]
    s_waitcnt lgkmcnt(6)
    v_mfma_f32_32x32x16_bf16 v[80:95], v[28:31], v[24:27], v[80:95]
    s_waitcnt lgkmcnt(3)
    v_mfma_f32_32x32x16_bf16 v[80:95], v[36:39], v[32:35], v[80:95]
    s_waitcnt lgkmcnt(0)
    v_mfma_f32_32x32x16_bf16 v[80:95], v[44:47], v[40:43], v[80:95]
    s_barrier
    ds_read_b128 v[48:51], v6 offset:49152
    ds_read_b64_tr_b16 v[52:53], v7 offset:49152
    ds_read_b64_tr_b16 v[54:55], v7 offset:50176
    ds_read_b128 v[56:59], v6 offset:50176
    ds_read_b64_tr_b16 v[60:61], v7 offset:51200
    ds_read_b64_tr_b16 v[62:63], v7 offset:52224
    ds_read_b128 v[64:67], v6 offset:51200
    ds_read_b64_tr_b16 v[68:69], v7 offset:53248
    ds_read_b64_tr_b16 v[70:71], v7 offset:54272
    ds_read_b128 v[72:75], v6 offset:52224
    ds_read_b64_tr_b16 v[76:77], v7 offset:55296
    ds_read_b64_tr_b16 v[78:79], v7 offset:56320
    s_waitcnt lgkmcnt(9)
k3_s9:
    s_cbranch_execz k3_end
    v_mfma_f32_32x32x16_bf16 v[80:95], v[52:55], v[48:51], v[80:95]
    s_waitcnt lgkmcnt(6)
    v_mfma_f32_32x32x16_bf16 v[80:95], v[60:63], v[56:59], v[80:95]
    s_waitcnt lgkmcnt(3)
    v_mfma_f32_32x32x16_bf16 v[80:95], v[68:71], v[64:67], v[80:95]
    s_waitcnt lgkmcnt(0)
    v_mfma_f32_32x32x16_bf16 v[80:95], v[76:79], v[72:75], v[80:95]
    s_nop 11
    v_cvt_pk_bf16_f32 v16, v80, v81
    v_cvt_pk_bf16_f32 v17, v82, v83
    v_cvt_pk_bf16_f32 v18, v84, v85
    v_cvt_pk_bf16_f32 v19, v86, v87
    ds_write_b128 v4, v[16:19]
    v_cvt_pk_bf16_f32 v20, v88, v89
    v_cvt_pk_bf16_f32 v21, v90, v91
    v_cvt_pk_bf16_f32 v22, v92, v93
    v_cvt_pk_bf16_f32 v23, v94, v95
    ds_write_b128 v4, v[20:23] offset:16
    ds_read_b128 v[24:27], v5
    ds_read_b128 v[28:31], v5 offset:1280
    s_waitcnt lgkmcnt(1)
    buffer_store_dwordx4 v[24:27], v8, s[52:55], s12 offen
    s_waitcnt lgkmcnt(0)
    buffer_store_dwordx4 v[28:31], v8, s[52:55], s13 offen
k3_end:
    s_endpgm
.section .rodata,"a"
.p2align 6
.amdhsa_kernel k1_kernel
  .amdhsa_next_free_vgpr 160
  .amdhsa_next_free_sgpr 102
  .amdhsa_accum_offset 160
  .amdhsa_group_segment_fixed_size 0
  .amdhsa_kernarg_size 120
  .amdhsa_user_sgpr_count 2
  .amdhsa_user_sgpr_kernarg_segment_ptr 1
  .amdhsa_system_sgpr_workgroup_id_x 1
.end_amdhsa_kernel
.p2align 6
.amdhsa_kernel k2_kernel
  .amdhsa_next_free_vgpr 128
  .amdhsa_next_free_sgpr 102
  .amdhsa_accum_offset 128
  .amdhsa_group_segment_fixed_size 0
  .amdhsa_kernarg_size 120
  .amdhsa_user_sgpr_count 2
  .amdhsa_user_sgpr_kernarg_segment_ptr 1
  .amdhsa_system_sgpr_workgroup_id_x 1
.end_amdhsa_kernel
.p2align 6
.amdhsa_kernel k3_kernel
  .amdhsa_next_free_vgpr 96
  .amdhsa_next_free_sgpr 102
  .amdhsa_accum_offset 96
  .amdhsa_group_segment_fixed_size 0
  .amdhsa_kernarg_size 120
  .amdhsa_user_sgpr_count 2
  .amdhsa_user_sgpr_kernarg_segment_ptr 1
  .amdhsa_system_sgpr_workgroup_id_x 1
.end_amdhsa_kernel
```
